```python
import torch

def _softmax(x, axis=-1):
    return torch.softmax(x, dim=axis)
def _gelu(x):
    return torch.nn.functional.gelu(x, approximate="tanh")
def _silu(x):
    return torch.nn.functional.silu(x)
def _sigmoid(x):
    return torch.sigmoid(x)
def _layernorm(x, axis=-1, eps=1e-5):
    m = x.mean(dim=axis, keepdim=True)
    v = x.var(dim=axis, keepdim=True, unbiased=False)
    return (x - m) / torch.sqrt(v + eps)
def _scatter_add(tgt, idx, src, axis=0):
    return tgt.clone().index_add_(axis, idx, src)
def _segment_sum(src, seg, n):
    out = torch.zeros((n,) + src.shape[1:], dtype=src.dtype)
    return out.index_add_(0, seg, src)
def _pad(x, pw):
    flat = tuple(v for pair in reversed(pw) for v in pair)
    return torch.nn.functional.pad(x, flat)

kernel_name = 'recurrent_scan__grouped_kv_mqa__dense_activation_relu__prompt'

def setup_inputs():

    _w = (lambda a: (lambda t: t.to(torch.bfloat16) if t.is_floating_point() else t)(torch.as_tensor(a)))
    def _A_setup():
        B, S, D, H = 1, 2048, 640, 32
        Dh = D // H
        return {
            "x": _w((lambda *s: torch.randn(*s, dtype=torch.bfloat16) * 0.05)(B, S, D)),
            "wq": _w((lambda *s: torch.randn(*s, dtype=torch.bfloat16) * 0.05)(D, H * Dh)),
            "wk": _w((lambda *s: torch.randn(*s, dtype=torch.bfloat16) * 0.05)(D, Dh)),
            "wv": _w((lambda *s: torch.randn(*s, dtype=torch.bfloat16) * 0.05)(D, Dh)),
            "wo": _w((lambda *s: torch.randn(*s, dtype=torch.bfloat16) * 0.05)(H * Dh, D)),
        }
    _A_in = _A_setup()

    def _B_setup():
        B, S, D, Dff = 1, 2048, 640, 1728
        return {
            "x": _w((lambda *s: torch.randn(*s, dtype=torch.bfloat16) * 0.05)(B, S, D)),
            "w1": _w((lambda *s: torch.randn(*s, dtype=torch.bfloat16) * 0.05)(D, Dff)),
            "w2": _w((lambda *s: torch.randn(*s, dtype=torch.bfloat16) * 0.05)(Dff, D)),
        }
    _B_in = _B_setup()

    return {
        "A_x": _A_in["x"],
        "A_wq": _A_in["wq"],
        "A_wk": _A_in["wk"],
        "A_wv": _A_in["wv"],
        "A_wo": _A_in["wo"],
        "B_x": _B_in["x"],
        "B_w1": _B_in["w1"],
        "B_w2": _B_in["w2"],
    }

def reference(A_x, A_wq, A_wk, A_wv, A_wo, B_x, B_w1, B_w2):
    def _A_ref(x, wq, wk, wv, wo):
        B, S, D = x.shape
        H = 32
        Dh = D // H
        q = (lambda x, *d: x.permute(*d))((x @ wq).reshape(B, S, H, Dh), 0, 2, 1, 3)
        k = x @ wk
        v = x @ wv
        scores = torch.einsum("bhqd,bkd->bhqk", q, k) * (Dh ** -0.5)
        p = _softmax(scores, axis=-1)
        o = torch.einsum("bhqk,bkd->bhqd", p, v)
        return (lambda x, *d: x.permute(*d))(o, 0, 2, 1, 3).reshape(B, S, H * Dh) @ wo

    def _B_ref(x, w1, w2):
        h = torch.einsum("bsd,df->bsf", x, w1)
        zero = torch.zeros_like(h)
        h = torch.maximum(h, zero)
        return torch.einsum("bsf,fd->bsd", h, w2)

    x = A_x
    xn = _layernorm(x, axis=-1)
    s = _A_ref(xn, A_wq, A_wk, A_wv, A_wo)
    g = _silu(_B_ref(xn, B_w1, B_w2))
    return x + s * g
```

```asm
; @launch grid=(256,1,1) block=(512,1,1) lds=163840
.amdgcn_target "amdgcn-amd-amdhsa--gfx950"
.text
.globl recurrent_scan__grouped_kv_mqa__dense_activation_relu__prompt_kernel
.p2align 8
.type recurrent_scan__grouped_kv_mqa__dense_activation_relu__prompt_kernel,@function
recurrent_scan__grouped_kv_mqa__dense_activation_relu__prompt_kernel:
    s_cmp_ge_u32 s2, 256
    s_cbranch_scc1 L_END
    s_load_dwordx16 s[40:55], s[0:1], 0
    s_load_dwordx4 s[56:59], s[0:1], 64
    s_load_dwordx2 s[60:61], s[0:1], 80
    v_lshrrev_b32 v1, 6, v0
    v_and_b32 v0, 63, v0
    s_and_b32 s62, s2, 1
    s_lshl_b32 s62, s62, 2
    s_lshr_b32 s63, s2, 6
    s_add_u32 s5, s62, s63
    v_readfirstlane_b32 s3, v1
    s_bfe_u32 s62, s2, 0x20001
    s_lshl_b32 s62, s62, 3
    s_bfe_u32 s63, s2, 0x30003
    s_add_u32 s4, s62, s63
    v_lshrrev_b32 v2, 3, v0
    v_and_b32 v3, 7, v0
    s_and_b32 s7, s3, 3
    s_and_b32 s65, s5, 1
    s_lshl_b32 s65, s65, 2
    s_xor_b32 s97, s65, s3
    s_lshl_b32 s62, s97, 3
    s_mul_i32 s98, s4, 81920
    v_add_u32 v4, s62, v2
    v_mul_u32_u24 v4, 1280, v4
    v_lshl_add_u32 v4, v3, 4, v4
    s_waitcnt lgkmcnt(0)
    s_mov_b32 s8, s40
    s_mov_b32 s9, s41
    s_mov_b32 s10, 2621440
    s_mov_b32 s11, 0x20000
    s_cmp_ge_u32 s3, 4
    s_cbranch_scc1 L_xa_1
    buffer_load_dwordx4 v[16:19], v4, s[8:11], s98 offen offset:0
    buffer_load_dwordx4 v[20:23], v4, s[8:11], s98 offen offset:128
    buffer_load_dwordx4 v[24:27], v4, s[8:11], s98 offen offset:256
    buffer_load_dwordx4 v[28:31], v4, s[8:11], s98 offen offset:384
    buffer_load_dwordx4 v[32:35], v4, s[8:11], s98 offen offset:512
    buffer_load_dwordx4 v[36:39], v4, s[8:11], s98 offen offset:640
    buffer_load_dwordx4 v[40:43], v4, s[8:11], s98 offen offset:768
    buffer_load_dwordx4 v[44:47], v4, s[8:11], s98 offen offset:896
    buffer_load_dwordx4 v[48:51], v4, s[8:11], s98 offen offset:1024
    buffer_load_dwordx4 v[52:55], v4, s[8:11], s98 offen offset:1152
L_xa_1:
    s_load_dword s6, s[60:61], 0
    s_mov_b32 s12, s42
    s_mov_b32 s13, s43
    s_mov_b32 s14, 819200
    s_mov_b32 s15, 0x20000
    s_cmp_eq_u32 s5, 4
    s_cselect_b32 s16, s46, s44
    s_cselect_b32 s17, s47, s45
    s_mov_b32 s18, 25600
    s_mov_b32 s19, 0x20000
    s_mov_b32 s20, s48
    s_mov_b32 s21, s49
    s_mov_b32 s22, 819200
    s_mov_b32 s23, 0x20000
    s_mov_b32 s24, s52
    s_mov_b32 s25, s53
    s_mov_b32 s26, 2211840
    s_mov_b32 s27, 0x20000
    s_mov_b32 s28, s54
    s_mov_b32 s29, s55
    s_mov_b32 s30, 2211840
    s_mov_b32 s31, 0x20000
    s_mov_b32 s32, s56
    s_mov_b32 s33, s57
    s_mov_b32 s34, 2621440
    s_mov_b32 s35, 0x20000
    s_mov_b32 s36, s60
    s_mov_b32 s37, s61
    s_mov_b32 s38, 20971520
    s_mov_b32 s39, 0x20000
    v_mov_b32 v200, 0
    v_mov_b32 v202, 0
    v_mov_b32 v230, 0
    v_mov_b32 v231, 0
    v_mov_b32 v253, 0
    v_mov_b32 v181, 0
    v_mov_b32 v215, 0
    v_mov_b32 v245, 0
    v_mov_b32 v220, 0
    v_mov_b32 v221, 0
    v_mov_b32 v222, 0
    v_mov_b32 v223, 0
    v_mov_b32 v224, 0
    v_mov_b32 v225, 0
    v_mov_b32 v226, 0
    v_mov_b32 v227, 0
    v_mov_b32 v228, 0
    v_mov_b32 v14, 0
    v_mov_b32 v15, 0
    v_mov_b32 v250, 0
    s_cmp_ge_u32 s3, 4
    s_cbranch_scc1 L_SET_B
    s_mul_i32 s66, s7, 11136
    s_add_u32 s66, s66, 118784
    v_lshrrev_b32 v216, 2, v0
    v_mul_u32_u24 v216, 1280, v216
    v_and_b32 v217, 3, v0
    v_cmp_eq_u32 vcc, 3, v217
    v_lshl_add_u32 v200, v217, 4, v216
    v_mov_b32 v217, 0x40000000
    v_cndmask_b32 v200, v200, v217, vcc
    s_lshl_b32 s62, s5, 2
    s_add_u32 s62, s62, s7
    s_mul_i32 s62, s62, 40
    s_cmp_eq_u32 s7, 3
    s_cselect_b32 s63, 8, 0
    s_sub_u32 s62, s62, s63
    v_add_u32 v200, s62, v200
    s_and_b32 s62, s4, 7
    s_lshr_b32 s63, s62, 2
    s_add_u32 s62, s62, s63
    s_lshl_b32 s69, s62, 2
    s_mul_i32 s67, s69, 20480
    v_lshlrev_b32 v212, 2, v0
    v_add_u32 v212, 163456, v212
    v_mov_b32 v213, 163328
    v_cmp_eq_u32 vcc, 0, v0
    v_mov_b32 v214, 1
    s_nop 0
    v_cndmask_b32 v212, v212, v213, vcc
    v_lshlrev_b32 v215, 4, v0
    v_and_b32 v216, 31, v0
    v_lshrrev_b32 v217, 5, v0
    v_add_u32 v204, 0, v217
    v_xor_b32 v204, v204, v216
    v_lshlrev_b32 v204, 4, v204
    v_lshl_add_u32 v204, v217, 9, v204
    v_add_u32 v208, 40960, v204
    v_add_u32 v205, 2, v217
    v_xor_b32 v205, v205, v216
    v_lshlrev_b32 v205, 4, v205
    v_lshl_add_u32 v205, v217, 9, v205
    v_add_u32 v209, 40960, v205
    v_add_u32 v206, 4, v217
    v_xor_b32 v206, v206, v216
    v_lshlrev_b32 v206, 4, v206
    v_lshl_add_u32 v206, v217, 9, v206
    v_add_u32 v210, 40960, v206
    v_add_u32 v207, 6, v217
    v_xor_b32 v207, v207, v216
    v_lshlrev_b32 v207, 4, v207
    v_lshl_add_u32 v207, v217, 9, v207
    v_add_u32 v211, 40960, v207
    s_lshl_b32 s62, s69, 10
    v_add_u32 v204, s62, v204
    v_add_u32 v208, s62, v208
    v_add_u32 v205, s62, v205
    v_add_u32 v209, s62, v209
    v_add_u32 v206, s62, v206
    v_add_u32 v210, s62, v210
    v_add_u32 v207, s62, v207
    v_add_u32 v211, s62, v211
    s_cmp_eq_u32 s7, 3
    s_cselect_b32 s63, 8, 0
    s_add_u32 s63, s63, s66
    v_lshrrev_b32 v216, 5, v0
    v_lshlrev_b32 v216, 3, v216
    v_bfe_u32 v217, v0, 2, 2
    v_add_u32 v216, v216, v217
    v_mul_u32_u24 v216, 64, v216
    v_bfe_u32 v217, v0, 4, 1
    v_lshl_add_u32 v216, v217, 5, v216
    v_and_b32 v217, 3, v0
    v_lshl_add_u32 v216, v217, 3, v216
    v_add_u32 v201, s63, v216
    v_add_u32 v172, 118784, v215
    v_and_b32 v216, 31, v0
    v_lshlrev_b32 v173, 4, v216
    v_add_u32 v173, 122880, v173
    v_min_u32 v217, 21, v216
    v_cmp_eq_u32 vcc, 24, v216
    v_lshrrev_b32 v219, 5, v0
    v_mul_u32_u24 v219, 352, v219
    v_mov_b32 v218, 20
    v_cndmask_b32 v217, v217, v218, vcc
    v_lshl_add_u32 v217, v217, 4, v219
    v_add_u32 v174, 123904, v217
    s_mul_i32 s62, s7, 2688
    v_add_u32 v181, s62, v215
    s_add_u32 s72, s62, 118784
    s_bfe_u32 s62, s2, 0x40003
    s_mul_i32 s79, s62, 12288
    s_add_u32 s79, s79, 65536
    s_branch L_SET_J
L_SET_B:
    s_mul_i32 s66, s7, 9216
    s_add_u32 s66, s66, 81920
    s_lshr_b32 s62, s5, 2
    s_sub_u32 s63, s5, s62
    s_sub_u32 s63, s63, 1
    s_lshl_b32 s63, s63, 2
    s_add_u32 s68, s63, s7
    s_mov_b32 s99, 1
    s_and_b32 s63, s5, 3
    s_cmp_lg_u32 s63, 0
    s_cbranch_scc1 L_pair_2
    s_lshl_b32 s62, s62, 1
    s_add_u32 s68, s62, s7
    s_add_u32 s68, s68, 22
    s_cmp_ge_u32 s7, 2
    s_cselect_b32 s99, 1, 0
    s_cmp_ge_u32 s68, 27
    s_cselect_b32 s99, 0, s99
    s_cselect_b32 s68, 0, s68
L_pair_2:
    s_lshl_b32 s68, s68, 1
    s_lshl_b32 s62, s68, 6
    v_lshrrev_b32 v246, 3, v0
    v_bfe_u32 v247, v0, 4, 1
    v_lshlrev_b32 v247, 2, v247
    v_and_b32 v248, 7, v0
    v_xor_b32 v247, v247, v248
    v_mul_u32_u24 v246, 3456, v246
    v_lshl_add_u32 v230, v247, 4, v246
    v_add_u32 v230, s62, v230
    v_add_u32 v231, 26624, v230
    v_lshlrev_b32 v242, 2, v0
    v_add_u32 v242, 163456, v242
    v_mov_b32 v243, 163328
    v_cmp_eq_u32 vcc, 0, v0
    v_mov_b32 v244, 1
    s_nop 0
    v_cndmask_b32 v242, v242, v243, vcc
    v_lshlrev_b32 v245, 4, v0
    s_and_b32 s62, s4, 7
    s_lshr_b32 s63, s62, 2
    s_add_u32 s62, s62, s63
    s_lshl_b32 s69, s62, 2
    s_mul_i32 s67, s69, 55296
    v_and_b32 v246, 31, v0
    v_lshrrev_b32 v247, 5, v0
    v_add_u32 v234, 0, v247
    v_xor_b32 v234, v234, v246
    v_lshlrev_b32 v234, 4, v234
    v_lshl_add_u32 v234, v247, 9, v234
    v_add_u32 v238, 40960, v234
    v_add_u32 v235, 2, v247
    v_xor_b32 v235, v235, v246
    v_lshlrev_b32 v235, 4, v235
    v_lshl_add_u32 v235, v247, 9, v235
    v_add_u32 v239, 40960, v235
    v_add_u32 v236, 4, v247
    v_xor_b32 v236, v236, v246
    v_lshlrev_b32 v236, 4, v236
    v_lshl_add_u32 v236, v247, 9, v236
    v_add_u32 v240, 40960, v236
    v_add_u32 v237, 6, v247
    v_xor_b32 v237, v237, v246
    v_lshlrev_b32 v237, 4, v237
    v_lshl_add_u32 v237, v247, 9, v237
    v_add_u32 v241, 40960, v237
    s_lshl_b32 s62, s69, 10
    v_add_u32 v234, s62, v234
    v_add_u32 v238, s62, v238
    v_add_u32 v235, s62, v235
    v_add_u32 v239, s62, v239
    v_add_u32 v236, s62, v236
    v_add_u32 v240, s62, v240
    v_add_u32 v237, s62, v237
    v_add_u32 v241, s62, v241
    v_lshrrev_b32 v246, 5, v0
    v_mul_u32_u24 v246, 8, v246
    v_bfe_u32 v247, v0, 2, 2
    v_add_u32 v246, v246, v247
    v_lshlrev_b32 v246, 7, v246
    v_bfe_u32 v247, v0, 4, 1
    v_lshlrev_b32 v247, 1, v247
    v_bfe_u32 v248, v0, 1, 1
    v_add_u32 v247, v247, v248
    v_bfe_u32 v248, v0, 3, 1
    v_lshlrev_b32 v248, 2, v248
    v_xor_b32 v247, v247, v248
    v_lshl_add_u32 v246, v247, 4, v246
    v_and_b32 v247, 1, v0
    v_lshl_add_u32 v246, v247, 3, v246
    v_add_u32 v232, s66, v246
    v_xor_b32 v233, 64, v246
    v_add_u32 v233, s66, v233
    s_mov_b32 s62, 81920
    v_lshrrev_b32 v246, 5, v0
    v_lshlrev_b32 v246, 3, v246
    v_bfe_u32 v247, v0, 2, 2
    v_add_u32 v246, v246, v247
    v_mul_u32_u24 v246, 40, v246
    v_bfe_u32 v247, v0, 4, 1
    v_lshl_add_u32 v246, v247, 5, v246
    v_and_b32 v247, 3, v0
    v_lshl_add_u32 v246, v247, 3, v246
    v_add_u32 v252, s62, v246
    s_and_b32 s64, s7, 1
    s_mul_i32 s64, s64, 40960
    v_and_b32 v246, 31, v0
    v_lshrrev_b32 v247, 5, v0
    v_add_u32 v112, 0, v247
    v_xor_b32 v112, v112, v246
    v_lshlrev_b32 v112, 4, v112
    v_lshl_add_u32 v112, v247, 9, v112
    v_add_u32 v112, s64, v112
    v_add_u32 v113, 2, v247
    v_xor_b32 v113, v113, v246
    v_lshlrev_b32 v113, 4, v113
    v_lshl_add_u32 v113, v247, 9, v113
    v_add_u32 v113, s64, v113
    v_add_u32 v114, 4, v247
    v_xor_b32 v114, v114, v246
    v_lshlrev_b32 v114, 4, v114
    v_lshl_add_u32 v114, v247, 9, v114
    v_add_u32 v114, s64, v114
    v_add_u32 v115, 6, v247
    v_xor_b32 v115, v115, v246
    v_lshlrev_b32 v115, 4, v115
    v_lshl_add_u32 v115, v247, 9, v115
    v_add_u32 v115, s64, v115
    v_lshlrev_b32 v253, 4, v0
    s_mul_i32 s62, s7, 6400
    v_add_u32 v253, s62, v253
    buffer_load_dwordx4 v[16:19], v4, s[8:11], s98 offen offset:0
    buffer_load_dwordx4 v[20:23], v4, s[8:11], s98 offen offset:128
    buffer_load_dwordx4 v[24:27], v4, s[8:11], s98 offen offset:256
    buffer_load_dwordx4 v[28:31], v4, s[8:11], s98 offen offset:384
    buffer_load_dwordx4 v[32:35], v4, s[8:11], s98 offen offset:512
    buffer_load_dwordx4 v[36:39], v4, s[8:11], s98 offen offset:640
    buffer_load_dwordx4 v[40:43], v4, s[8:11], s98 offen offset:768
    buffer_load_dwordx4 v[44:47], v4, s[8:11], s98 offen offset:896
    buffer_load_dwordx4 v[48:51], v4, s[8:11], s98 offen offset:1024
    buffer_load_dwordx4 v[52:55], v4, s[8:11], s98 offen offset:1152
    s_and_b32 s64, s5, 3
    s_cmp_lg_u32 s64, 0
    s_cbranch_scc1 L_SET_NK
    s_add_u32 s63, s62, 81920
    s_mov_b32 m0, s63
    s_mov_b32 s62, 0
    buffer_load_dwordx4 v253, s[16:19], s62 offen offset:0 lds
    buffer_load_dwordx4 v253, s[16:19], s62 offen offset:1024 lds
    buffer_load_dwordx4 v253, s[16:19], s62 offen offset:2048 lds
    buffer_load_dwordx4 v253, s[16:19], s62 offen offset:3072 lds
    s_add_u32 m0, s63, 4096
    s_mov_b32 s62, 4096
    buffer_load_dwordx4 v253, s[16:19], s62 offen offset:0 lds
    buffer_load_dwordx4 v253, s[16:19], s62 offen offset:1024 lds
    buffer_load_dwordx4 v253, s[16:19], s62 offen offset:2048 lds
L_SET_NK:
    s_lshr_b32 s62, s5, 1
    s_and_b32 s64, s62, 1
    s_mul_i32 s62, s62, 5
    s_and_b32 s82, s5, 1
    s_lshl_b32 s63, s82, 1
    s_add_u32 s80, s62, s63
    s_add_u32 s80, s80, s64
    s_lshl_b32 s80, s80, 6
    s_xor_b32 s64, s64, 1
    s_lshl_b32 s64, s64, 2
    s_add_u32 s81, s62, s64
    s_lshl_b32 s81, s81, 6
    s_mul_i32 s83, s7, 29696
    v_lshrrev_b32 v246, 3, v0
    v_bfe_u32 v247, v0, 4, 1
    v_lshlrev_b32 v247, 2, v247
    v_and_b32 v248, 7, v0
    v_xor_b32 v247, v247, v248
    v_mul_u32_u24 v246, 1280, v246
    v_lshl_add_u32 v220, v247, 4, v246
    v_add_u32 v220, s80, v220
    v_add_u32 v221, 9216, v220
    v_lshrrev_b32 v246, 2, v0
    v_mul_u32_u24 v246, 1280, v246
    v_and_b32 v247, 3, v0
    v_lshl_add_u32 v222, v247, 4, v246
    v_add_u32 v222, s81, v222
    v_lshrrev_b32 v246, 5, v0
    v_mul_u32_u24 v246, 4, v246
    v_bfe_u32 v247, v0, 2, 2
    v_add_u32 v246, v246, v247
    v_lshlrev_b32 v246, 7, v246
    v_bfe_u32 v247, v0, 4, 1
    v_lshlrev_b32 v247, 1, v247
    v_bfe_u32 v248, v0, 1, 1
    v_add_u32 v247, v247, v248
    v_bfe_u32 v248, v0, 3, 1
    v_lshlrev_b32 v248, 2, v248
    v_xor_b32 v247, v247, v248
    v_lshl_add_u32 v246, v247, 4, v246
    v_and_b32 v247, 1, v0
    v_lshl_add_u32 v246, v247, 3, v246
    v_add_u32 v8, s83, v246
    v_xor_b32 v9, 64, v246
    v_add_u32 v9, s83, v9
    v_lshrrev_b32 v246, 5, v0
    v_lshlrev_b32 v246, 2, v246
    v_bfe_u32 v247, v0, 2, 2
    v_add_u32 v246, v246, v247
    v_lshlrev_b32 v246, 6, v246
    v_bfe_u32 v247, v0, 4, 1
    v_lshl_add_u32 v246, v247, 5, v246
    v_and_b32 v247, 3, v0
    v_lshl_add_u32 v246, v247, 3, v246
    s_add_u32 s62, s83, 2048
    v_add_u32 v10, s62, v246
    v_add_u32 v11, s83, v245
    s_lshl_b32 s62, s7, 12
    v_add_u32 v12, s62, v245
    v_add_u32 v13, 59392, v12
    s_lshl_b32 s62, s7, 10
    s_add_u32 s62, s62, 16384
    v_add_u32 v254, s62, v245
    v_add_u32 v255, 59392, v254
    v_lshrrev_b32 v246, 3, v0
    v_lshrrev_b32 v247, 2, v246
    v_mul_u32_u24 v247, 40, v247
    v_and_b32 v248, 3, v246
    v_add3_u32 v247, v247, v248, 16
    v_mul_u32_u24 v247, 1280, v247
    v_bfe_u32 v248, v0, 4, 1
    v_lshlrev_b32 v248, 2, v248
    v_and_b32 v249, 7, v0
    v_xor_b32 v248, v248, v249
    v_lshl_add_u32 v223, v248, 4, v247
    v_add_u32 v223, s80, v223
    v_add_u32 v224, 24576, v223
    v_lshrrev_b32 v246, 2, v0
    v_bfe_u32 v247, v246, 2, 1
    v_lshlrev_b32 v247, 1, v247
    v_lshrrev_b32 v248, 3, v246
    v_add_u32 v247, v247, v248
    v_mul_u32_u24 v247, 20, v247
    v_and_b32 v248, 3, v246
    v_add3_u32 v247, v247, v248, 16
    v_mul_u32_u24 v247, 1280, v247
    v_and_b32 v248, 3, v0
    v_lshl_add_u32 v225, v248, 4, v247
    v_add_u32 v225, s81, v225
    v_and_b32 v246, 31, v0
    v_mul_u32_u24 v246, 1280, v246
    v_lshrrev_b32 v247, 5, v0
    v_lshl_add_u32 v14, v247, 3, v246
    s_lshl_b32 s62, s4, 1
    s_add_u32 s63, s62, s82
    s_xor_b32 s64, s82, 1
    s_add_u32 s64, s62, s64
    s_mul_i32 s85, s63, 110592
    s_mul_i32 s86, s64, 110592
    s_mul_i32 s62, s7, 27648
    s_add_u32 s62, s62, 1048576
    s_add_u32 s85, s85, s62
    s_add_u32 s86, s86, s62
    v_add_u32 v15, s85, v245
    v_add_u32 v250, s86, v245
    s_and_b32 s64, s5, 3
    s_cmp_lg_u32 s64, 0
    s_cbranch_scc1 L_SET_J
    s_waitcnt vmcnt(7)
    s_branch L_SET_X
L_SET_J:
    s_waitcnt vmcnt(0)
L_SET_X:
    s_waitcnt lgkmcnt(0)
    s_add_u32 s6, s6, 1
    v_lshrrev_b32 v5, 1, v3
    v_lshlrev_b32 v5, 10, v5
    v_and_b32 v6, 1, v3
    v_lshlrev_b32 v6, 9, v6
    v_xor_b32 v7, v2, v3
    v_lshlrev_b32 v7, 4, v7
    v_add3_u32 v5, v5, v6, v7
    s_and_b32 s62, s97, 3
    s_lshl_b32 s62, s62, 7
    s_lshr_b32 s64, s97, 2
    s_mul_i32 s64, s64, 40960
    s_add_u32 s62, s62, s64
    v_add_u32 v5, s62, v5
    s_cmp_lg_u32 s3, 0
    s_cbranch_scc1 L_nz_3
    v_lshlrev_b32 v6, 2, v0
    v_add_u32 v6, 163328, v6
    v_mov_b32 v7, 0
    ds_write_b32 v6, v7
L_nz_3:
    s_mov_b32 s62, 0x3f803f80
    s_mov_b32 s63, 0xffff0000
    v_mov_b32 v64, 0
    v_mov_b32 v65, 0
    v_mov_b32 v66, 0
    v_mov_b32 v67, 0
    s_nop 0
    v_dot2_f32_bf16 v64, v16, s62, v64
    v_dot2_f32_bf16 v66, v16, v16, v66
    v_dot2_f32_bf16 v65, v17, s62, v65
    v_dot2_f32_bf16 v67, v17, v17, v67
    v_dot2_f32_bf16 v64, v18, s62, v64
    v_dot2_f32_bf16 v66, v18, v18, v66
    v_dot2_f32_bf16 v65, v19, s62, v65
    v_dot2_f32_bf16 v67, v19, v19, v67
    v_dot2_f32_bf16 v64, v20, s62, v64
    v_dot2_f32_bf16 v66, v20, v20, v66
    v_dot2_f32_bf16 v65, v21, s62, v65
    v_dot2_f32_bf16 v67, v21, v21, v67
    v_dot2_f32_bf16 v64, v22, s62, v64
    v_dot2_f32_bf16 v66, v22, v22, v66
    v_dot2_f32_bf16 v65, v23, s62, v65
    v_dot2_f32_bf16 v67, v23, v23, v67
    v_dot2_f32_bf16 v64, v24, s62, v64
    v_dot2_f32_bf16 v66, v24, v24, v66
    v_dot2_f32_bf16 v65, v25, s62, v65
    v_dot2_f32_bf16 v67, v25, v25, v67
    v_dot2_f32_bf16 v64, v26, s62, v64
    v_dot2_f32_bf16 v66, v26, v26, v66
    v_dot2_f32_bf16 v65, v27, s62, v65
    v_dot2_f32_bf16 v67, v27, v27, v67
    v_dot2_f32_bf16 v64, v28, s62, v64
    v_dot2_f32_bf16 v66, v28, v28, v66
    v_dot2_f32_bf16 v65, v29, s62, v65
    v_dot2_f32_bf16 v67, v29, v29, v67
    v_dot2_f32_bf16 v64, v30, s62, v64
    v_dot2_f32_bf16 v66, v30, v30, v66
    v_dot2_f32_bf16 v65, v31, s62, v65
    v_dot2_f32_bf16 v67, v31, v31, v67
    v_dot2_f32_bf16 v64, v32, s62, v64
    v_dot2_f32_bf16 v66, v32, v32, v66
    v_dot2_f32_bf16 v65, v33, s62, v65
    v_dot2_f32_bf16 v67, v33, v33, v67
    v_dot2_f32_bf16 v64, v34, s62, v64
    v_dot2_f32_bf16 v66, v34, v34, v66
    v_dot2_f32_bf16 v65, v35, s62, v65
    v_dot2_f32_bf16 v67, v35, v35, v67
    v_dot2_f32_bf16 v64, v36, s62, v64
    v_dot2_f32_bf16 v66, v36, v36, v66
    v_dot2_f32_bf16 v65, v37, s62, v65
    v_dot2_f32_bf16 v67, v37, v37, v67
    v_dot2_f32_bf16 v64, v38, s62, v64
    v_dot2_f32_bf16 v66, v38, v38, v66
    v_dot2_f32_bf16 v65, v39, s62, v65
    v_dot2_f32_bf16 v67, v39, v39, v67
    v_dot2_f32_bf16 v64, v40, s62, v64
    v_dot2_f32_bf16 v66, v40, v40, v66
    v_dot2_f32_bf16 v65, v41, s62, v65
    v_dot2_f32_bf16 v67, v41, v41, v67
    v_dot2_f32_bf16 v64, v42, s62, v64
    v_dot2_f32_bf16 v66, v42, v42, v66
    v_dot2_f32_bf16 v65, v43, s62, v65
    v_dot2_f32_bf16 v67, v43, v43, v67
    v_dot2_f32_bf16 v64, v44, s62, v64
    v_dot2_f32_bf16 v66, v44, v44, v66
    v_dot2_f32_bf16 v65, v45, s62, v65
    v_dot2_f32_bf16 v67, v45, v45, v67
    v_dot2_f32_bf16 v64, v46, s62, v64
    v_dot2_f32_bf16 v66, v46, v46, v66
    v_dot2_f32_bf16 v65, v47, s62, v65
    v_dot2_f32_bf16 v67, v47, v47, v67
    v_dot2_f32_bf16 v64, v48, s62, v64
    v_dot2_f32_bf16 v66, v48, v48, v66
    v_dot2_f32_bf16 v65, v49, s62, v65
    v_dot2_f32_bf16 v67, v49, v49, v67
    v_dot2_f32_bf16 v64, v50, s62, v64
    v_dot2_f32_bf16 v66, v50, v50, v66
    v_dot2_f32_bf16 v65, v51, s62, v65
    v_dot2_f32_bf16 v67, v51, v51, v67
    v_dot2_f32_bf16 v64, v52, s62, v64
    v_dot2_f32_bf16 v66, v52, v52, v66
    v_dot2_f32_bf16 v65, v53, s62, v65
    v_dot2_f32_bf16 v67, v53, v53, v67
    v_dot2_f32_bf16 v64, v54, s62, v64
    v_dot2_f32_bf16 v66, v54, v54, v66
    v_dot2_f32_bf16 v65, v55, s62, v65
    v_dot2_f32_bf16 v67, v55, v55, v67
    s_nop 2
    v_add_f32 v64, v64, v65
    v_add_f32 v66, v66, v67
    s_nop 0
    v_add_f32_dpp v64, v64, v64 quad_perm:[1,0,3,2] row_mask:0xf bank_mask:0xf
    v_add_f32_dpp v66, v66, v66 quad_perm:[1,0,3,2] row_mask:0xf bank_mask:0xf
    s_nop 0
    v_add_f32_dpp v64, v64, v64 quad_perm:[2,3,0,1] row_mask:0xf bank_mask:0xf
    v_add_f32_dpp v66, v66, v66 quad_perm:[2,3,0,1] row_mask:0xf bank_mask:0xf
    s_nop 0
    v_add_f32_dpp v64, v64, v64 row_half_mirror row_mask:0xf bank_mask:0xf
    v_add_f32_dpp v66, v66, v66 row_half_mirror row_mask:0xf bank_mask:0xf
    s_nop 0
    v_mul_f32 v64, 0x3acccccd, v64
    v_mul_f32 v66, 0x3acccccd, v66
    v_fma_f32 v66, -v64, v64, v66
    v_max_f32 v66, 0, v66
    v_add_f32 v66, 0x3727c5ac, v66
    v_rsq_f32 v68, v66
    s_nop 0
    v_mov_b32 v69, v68
    v_mul_f32 v70, v64, v68
    v_sub_f32 v70, 0, v70
    v_mov_b32 v71, v70
    s_cmp_ge_u32 s3, 4
    s_cbranch_scc1 L_pfb_4
    s_add_u32 m0, s66, 0
    s_nop 0
    buffer_load_dwordx4 v200, s[12:15], s67 offen lds
    s_add_u32 s67, s67, 20480
    s_add_u32 m0, s66, 1024
    s_nop 0
    buffer_load_dwordx4 v200, s[12:15], s67 offen lds
    s_add_u32 s67, s67, 20480
    s_add_u32 m0, s66, 2048
    s_nop 0
    buffer_load_dwordx4 v200, s[12:15], s67 offen lds
    s_add_u32 s67, s67, 20480
    s_add_u32 m0, s66, 3072
    s_nop 0
    buffer_load_dwordx4 v200, s[12:15], s67 offen lds
    s_add_u32 s67, s67, 20480
    s_add_u32 m0, s66, 4096
    s_nop 0
    buffer_load_dwordx4 v200, s[12:15], s67 offen lds
    s_add_u32 s67, s67, 20480
    s_add_u32 m0, s66, 5120
    s_nop 0
    buffer_load_dwordx4 v200, s[12:15], s67 offen lds
    s_add_u32 s67, s67, 20480
    s_add_u32 m0, s66, 6144
    s_nop 0
    buffer_load_dwordx4 v200, s[12:15], s67 offen lds
    s_add_u32 s67, s67, 20480
    s_add_u32 m0, s66, 7168
    s_nop 0
    buffer_load_dwordx4 v200, s[12:15], s67 offen lds
    s_add_u32 s67, s67, 20480
    s_cmp_eq_u32 s67, 819200
    s_cselect_b32 s67, 0, s67
    s_add_u32 m0, s66, 8192
    s_nop 0
    buffer_load_dwordx4 v200, s[12:15], s67 offen lds
    s_add_u32 s67, s67, 20480
    s_add_u32 m0, s66, 9216
    s_nop 0
    buffer_load_dwordx4 v200, s[12:15], s67 offen lds
    s_add_u32 s67, s67, 20480
    s_branch L_LN2
L_pfb_4:
L_LN2:
    s_mov_b32 s63, 0xffff0000
    v_lshlrev_b32 v56, 16, v16
    v_and_b32 v57, s63, v16
    v_lshlrev_b32 v58, 16, v17
    v_and_b32 v59, s63, v17
    v_lshlrev_b32 v60, 16, v18
    v_and_b32 v61, s63, v18
    v_lshlrev_b32 v62, 16, v19
    v_and_b32 v63, s63, v19
    v_pk_fma_f32 v[56:57], v[56:57], v[68:69], v[70:71]
    v_pk_fma_f32 v[58:59], v[58:59], v[68:69], v[70:71]
    v_pk_fma_f32 v[60:61], v[60:61], v[68:69], v[70:71]
    v_pk_fma_f32 v[62:63], v[62:63], v[68:69], v[70:71]
    v_cvt_pk_bf16_f32 v16, v56, v57
    v_cvt_pk_bf16_f32 v17, v58, v59
    v_cvt_pk_bf16_f32 v18, v60, v61
    v_cvt_pk_bf16_f32 v19, v62, v63
    ds_write_b128 v5, v[16:19] offset:0
    v_lshlrev_b32 v56, 16, v20
    v_and_b32 v57, s63, v20
    v_lshlrev_b32 v58, 16, v21
    v_and_b32 v59, s63, v21
    v_lshlrev_b32 v60, 16, v22
    v_and_b32 v61, s63, v22
    v_lshlrev_b32 v62, 16, v23
    v_and_b32 v63, s63, v23
    v_pk_fma_f32 v[56:57], v[56:57], v[68:69], v[70:71]
    v_pk_fma_f32 v[58:59], v[58:59], v[68:69], v[70:71]
    v_pk_fma_f32 v[60:61], v[60:61], v[68:69], v[70:71]
    v_pk_fma_f32 v[62:63], v[62:63], v[68:69], v[70:71]
    v_cvt_pk_bf16_f32 v20, v56, v57
    v_cvt_pk_bf16_f32 v21, v58, v59
    v_cvt_pk_bf16_f32 v22, v60, v61
    v_cvt_pk_bf16_f32 v23, v62, v63
    ds_write_b128 v5, v[20:23] offset:4096
    v_lshlrev_b32 v56, 16, v24
    v_and_b32 v57, s63, v24
    v_lshlrev_b32 v58, 16, v25
    v_and_b32 v59, s63, v25
    v_lshlrev_b32 v60, 16, v26
    v_and_b32 v61, s63, v26
    v_lshlrev_b32 v62, 16, v27
    v_and_b32 v63, s63, v27
    v_pk_fma_f32 v[56:57], v[56:57], v[68:69], v[70:71]
    v_pk_fma_f32 v[58:59], v[58:59], v[68:69], v[70:71]
    v_pk_fma_f32 v[60:61], v[60:61], v[68:69], v[70:71]
    v_pk_fma_f32 v[62:63], v[62:63], v[68:69], v[70:71]
    v_cvt_pk_bf16_f32 v24, v56, v57
    v_cvt_pk_bf16_f32 v25, v58, v59
    v_cvt_pk_bf16_f32 v26, v60, v61
    v_cvt_pk_bf16_f32 v27, v62, v63
    ds_write_b128 v5, v[24:27] offset:8192
    v_lshlrev_b32 v56, 16, v28
    v_and_b32 v57, s63, v28
    v_lshlrev_b32 v58, 16, v29
    v_and_b32 v59, s63, v29
    v_lshlrev_b32 v60, 16, v30
    v_and_b32 v61, s63, v30
    v_lshlrev_b32 v62, 16, v31
    v_and_b32 v63, s63, v31
    v_pk_fma_f32 v[56:57], v[56:57], v[68:69], v[70:71]
    v_pk_fma_f32 v[58:59], v[58:59], v[68:69], v[70:71]
    v_pk_fma_f32 v[60:61], v[60:61], v[68:69], v[70:71]
    v_pk_fma_f32 v[62:63], v[62:63], v[68:69], v[70:71]
    v_cvt_pk_bf16_f32 v28, v56, v57
    v_cvt_pk_bf16_f32 v29, v58, v59
    v_cvt_pk_bf16_f32 v30, v60, v61
    v_cvt_pk_bf16_f32 v31, v62, v63
    ds_write_b128 v5, v[28:31] offset:12288
    v_lshlrev_b32 v56, 16, v32
    v_and_b32 v57, s63, v32
    v_lshlrev_b32 v58, 16, v33
    v_and_b32 v59, s63, v33
    v_lshlrev_b32 v60, 16, v34
    v_and_b32 v61, s63, v34
    v_lshlrev_b32 v62, 16, v35
    v_and_b32 v63, s63, v35
    v_pk_fma_f32 v[56:57], v[56:57], v[68:69], v[70:71]
    v_pk_fma_f32 v[58:59], v[58:59], v[68:69], v[70:71]
    v_pk_fma_f32 v[60:61], v[60:61], v[68:69], v[70:71]
    v_pk_fma_f32 v[62:63], v[62:63], v[68:69], v[70:71]
    v_cvt_pk_bf16_f32 v32, v56, v57
    v_cvt_pk_bf16_f32 v33, v58, v59
    v_cvt_pk_bf16_f32 v34, v60, v61
    v_cvt_pk_bf16_f32 v35, v62, v63
    ds_write_b128 v5, v[32:35] offset:16384
    v_lshlrev_b32 v56, 16, v36
    v_and_b32 v57, s63, v36
    v_lshlrev_b32 v58, 16, v37
    v_and_b32 v59, s63, v37
    v_lshlrev_b32 v60, 16, v38
    v_and_b32 v61, s63, v38
    v_lshlrev_b32 v62, 16, v39
    v_and_b32 v63, s63, v39
    v_pk_fma_f32 v[56:57], v[56:57], v[68:69], v[70:71]
    v_pk_fma_f32 v[58:59], v[58:59], v[68:69], v[70:71]
    v_pk_fma_f32 v[60:61], v[60:61], v[68:69], v[70:71]
    v_pk_fma_f32 v[62:63], v[62:63], v[68:69], v[70:71]
    v_cvt_pk_bf16_f32 v36, v56, v57
    v_cvt_pk_bf16_f32 v37, v58, v59
    v_cvt_pk_bf16_f32 v38, v60, v61
    v_cvt_pk_bf16_f32 v39, v62, v63
    ds_write_b128 v5, v[36:39] offset:20480
    v_lshlrev_b32 v56, 16, v40
    v_and_b32 v57, s63, v40
    v_lshlrev_b32 v58, 16, v41
    v_and_b32 v59, s63, v41
    v_lshlrev_b32 v60, 16, v42
    v_and_b32 v61, s63, v42
    v_lshlrev_b32 v62, 16, v43
    v_and_b32 v63, s63, v43
    v_pk_fma_f32 v[56:57], v[56:57], v[68:69], v[70:71]
    v_pk_fma_f32 v[58:59], v[58:59], v[68:69], v[70:71]
    v_pk_fma_f32 v[60:61], v[60:61], v[68:69], v[70:71]
    v_pk_fma_f32 v[62:63], v[62:63], v[68:69], v[70:71]
    v_cvt_pk_bf16_f32 v40, v56, v57
    v_cvt_pk_bf16_f32 v41, v58, v59
    v_cvt_pk_bf16_f32 v42, v60, v61
    v_cvt_pk_bf16_f32 v43, v62, v63
    ds_write_b128 v5, v[40:43] offset:24576
    v_lshlrev_b32 v56, 16, v44
    v_and_b32 v57, s63, v44
    v_lshlrev_b32 v58, 16, v45
    v_and_b32 v59, s63, v45
    v_lshlrev_b32 v60, 16, v46
    v_and_b32 v61, s63, v46
    v_lshlrev_b32 v62, 16, v47
    v_and_b32 v63, s63, v47
    v_pk_fma_f32 v[56:57], v[56:57], v[68:69], v[70:71]
    v_pk_fma_f32 v[58:59], v[58:59], v[68:69], v[70:71]
    v_pk_fma_f32 v[60:61], v[60:61], v[68:69], v[70:71]
    v_pk_fma_f32 v[62:63], v[62:63], v[68:69], v[70:71]
    v_cvt_pk_bf16_f32 v44, v56, v57
    v_cvt_pk_bf16_f32 v45, v58, v59
    v_cvt_pk_bf16_f32 v46, v60, v61
    v_cvt_pk_bf16_f32 v47, v62, v63
    ds_write_b128 v5, v[44:47] offset:28672
    v_lshlrev_b32 v56, 16, v48
    v_and_b32 v57, s63, v48
    v_lshlrev_b32 v58, 16, v49
    v_and_b32 v59, s63, v49
    v_lshlrev_b32 v60, 16, v50
    v_and_b32 v61, s63, v50
    v_lshlrev_b32 v62, 16, v51
    v_and_b32 v63, s63, v51
    v_pk_fma_f32 v[56:57], v[56:57], v[68:69], v[70:71]
    v_pk_fma_f32 v[58:59], v[58:59], v[68:69], v[70:71]
    v_pk_fma_f32 v[60:61], v[60:61], v[68:69], v[70:71]
    v_pk_fma_f32 v[62:63], v[62:63], v[68:69], v[70:71]
    v_cvt_pk_bf16_f32 v48, v56, v57
    v_cvt_pk_bf16_f32 v49, v58, v59
    v_cvt_pk_bf16_f32 v50, v60, v61
    v_cvt_pk_bf16_f32 v51, v62, v63
    ds_write_b128 v5, v[48:51] offset:32768
    v_lshlrev_b32 v56, 16, v52
    v_and_b32 v57, s63, v52
    v_lshlrev_b32 v58, 16, v53
    v_and_b32 v59, s63, v53
    v_lshlrev_b32 v60, 16, v54
    v_and_b32 v61, s63, v54
    v_lshlrev_b32 v62, 16, v55
    v_and_b32 v63, s63, v55
    v_pk_fma_f32 v[56:57], v[56:57], v[68:69], v[70:71]
    v_pk_fma_f32 v[58:59], v[58:59], v[68:69], v[70:71]
    v_pk_fma_f32 v[60:61], v[60:61], v[68:69], v[70:71]
    v_pk_fma_f32 v[62:63], v[62:63], v[68:69], v[70:71]
    v_cvt_pk_bf16_f32 v52, v56, v57
    v_cvt_pk_bf16_f32 v53, v58, v59
    v_cvt_pk_bf16_f32 v54, v60, v61
    v_cvt_pk_bf16_f32 v55, v62, v63
    ds_write_b128 v5, v[52:55] offset:36864
    s_waitcnt lgkmcnt(0)
    s_cmp_lt_u32 s3, 4
    s_cbranch_scc1 L_nw_5
    s_and_b32 s62, s5, 3
    s_cmp_lg_u32 s62, 0
    s_cbranch_scc1 L_nw_5
    s_waitcnt vmcnt(0)
L_nw_5:
    s_barrier
    s_cmp_ge_u32 s3, 4
    s_cbranch_scc1 L_ROLE_B
L_ROLE_A:
    s_setprio 2
    s_waitcnt vmcnt(9)
    ds_read_b64_tr_b16 v[48:49], v201 offset:0
    ds_read_b64_tr_b16 v[50:51], v201 offset:256
    ds_read_b128 v[52:55], v204 offset:0
    ds_read_b128 v[56:59], v208 offset:0
    s_waitcnt vmcnt(8)
    ds_read_b64_tr_b16 v[60:61], v201 offset:1024
    ds_read_b64_tr_b16 v[62:63], v201 offset:1280
    ds_read_b128 v[64:67], v205 offset:1024
    ds_read_b128 v[68:71], v209 offset:1024
    s_waitcnt lgkmcnt(4)
    v_mfma_f32_32x32x16_bf16 v[16:31], v[48:51], v[52:55], 0
    s_waitcnt vmcnt(7)
    ds_read_b64_tr_b16 v[72:73], v201 offset:2048
    ds_read_b64_tr_b16 v[74:75], v201 offset:2304
    ds_read_b128 v[76:79], v206 offset:2048
    ds_read_b128 v[80:83], v210 offset:2048
    v_mfma_f32_32x32x16_bf16 v[32:47], v[48:51], v[56:59], 0
    s_add_u32 m0, s66, 0
    s_nop 0
    buffer_load_dwordx4 v200, s[12:15], s67 offen lds
    s_add_u32 s67, s67, 20480
    s_waitcnt lgkmcnt(4)
    v_mfma_f32_32x32x16_bf16 v[16:31], v[60:63], v[64:67], v[16:31]
    s_waitcnt vmcnt(7)
    ds_read_b64_tr_b16 v[48:49], v201 offset:3072
    ds_read_b64_tr_b16 v[50:51], v201 offset:3328
    ds_read_b128 v[52:55], v207 offset:3072
    ds_read_b128 v[56:59], v211 offset:3072
    v_mfma_f32_32x32x16_bf16 v[32:47], v[60:63], v[68:71], v[32:47]
    s_add_u32 m0, s66, 1024
    s_nop 0
    buffer_load_dwordx4 v200, s[12:15], s67 offen lds
    s_add_u32 s67, s67, 20480
    s_cmp_eq_u32 s67, 819200
    s_cselect_b32 s67, 0, s67
    s_waitcnt lgkmcnt(4)
    v_mfma_f32_32x32x16_bf16 v[16:31], v[72:75], v[76:79], v[16:31]
    s_waitcnt vmcnt(7)
    ds_read_b64_tr_b16 v[60:61], v201 offset:4096
    ds_read_b64_tr_b16 v[62:63], v201 offset:4352
    ds_read_b128 v[64:67], v204 offset:4096
    ds_read_b128 v[68:71], v208 offset:4096
    v_mfma_f32_32x32x16_bf16 v[32:47], v[72:75], v[80:83], v[32:47]
    s_add_u32 m0, s66, 2048
    s_nop 0
    buffer_load_dwordx4 v200, s[12:15], s67 offen lds
    s_add_u32 s67, s67, 20480
    s_waitcnt lgkmcnt(4)
    v_mfma_f32_32x32x16_bf16 v[16:31], v[48:51], v[52:55], v[16:31]
    s_waitcnt vmcnt(7)
    ds_read_b64_tr_b16 v[72:73], v201 offset:5120
    ds_read_b64_tr_b16 v[74:75], v201 offset:5376
    ds_read_b128 v[76:79], v205 offset:5120
    ds_read_b128 v[80:83], v209 offset:5120
    v_mfma_f32_32x32x16_bf16 v[32:47], v[48:51], v[56:59], v[32:47]
    s_add_u32 m0, s66, 3072
    s_nop 0
    buffer_load_dwordx4 v200, s[12:15], s67 offen lds
    s_add_u32 s67, s67, 20480
    s_waitcnt lgkmcnt(4)
    v_mfma_f32_32x32x16_bf16 v[16:31], v[60:63], v[64:67], v[16:31]
    s_waitcnt vmcnt(7)
    ds_read_b64_tr_b16 v[48:49], v201 offset:6144
    ds_read_b64_tr_b16 v[50:51], v201 offset:6400
    ds_read_b128 v[52:55], v206 offset:6144
    ds_read_b128 v[56:59], v210 offset:6144
    v_mfma_f32_32x32x16_bf16 v[32:47], v[60:63], v[68:71], v[32:47]
    s_add_u32 m0, s66, 4096
    s_nop 0
    buffer_load_dwordx4 v200, s[12:15], s67 offen lds
    s_add_u32 s67, s67, 20480
    s_waitcnt lgkmcnt(4)
    v_mfma_f32_32x32x16_bf16 v[16:31], v[72:75], v[76:79], v[16:31]
    s_waitcnt vmcnt(7)
    ds_read_b64_tr_b16 v[60:61], v201 offset:7168
    ds_read_b64_tr_b16 v[62:63], v201 offset:7424
    ds_read_b128 v[64:67], v207 offset:7168
    ds_read_b128 v[68:71], v211 offset:7168
    v_mfma_f32_32x32x16_bf16 v[32:47], v[72:75], v[80:83], v[32:47]
    s_add_u32 m0, s66, 5120
    s_nop 0
    buffer_load_dwordx4 v200, s[12:15], s67 offen lds
    s_add_u32 s67, s67, 20480
    s_cmp_eq_u32 s67, 819200
    s_cselect_b32 s67, 0, s67
    s_waitcnt lgkmcnt(4)
    v_mfma_f32_32x32x16_bf16 v[16:31], v[48:51], v[52:55], v[16:31]
    s_waitcnt vmcnt(7)
    ds_read_b64_tr_b16 v[72:73], v201 offset:8192
    ds_read_b64_tr_b16 v[74:75], v201 offset:8448
    s_cmp_eq_u32 s69, 32
    s_cbranch_scc0 L_wrap_6
    v_subrev_u32 v204, 40960, v204
    v_subrev_u32 v208, 40960, v208
    v_subrev_u32 v205, 40960, v205
    v_subrev_u32 v209, 40960, v209
    v_subrev_u32 v206, 40960, v206
    v_subrev_u32 v210, 40960, v210
    v_subrev_u32 v207, 40960, v207
    v_subrev_u32 v211, 40960, v211
L_wrap_6:
    ds_read_b128 v[76:79], v204 offset:8192
    ds_read_b128 v[80:83], v208 offset:8192
    v_mfma_f32_32x32x16_bf16 v[32:47], v[48:51], v[56:59], v[32:47]
    s_add_u32 m0, s66, 6144
    s_nop 0
    buffer_load_dwordx4 v200, s[12:15], s67 offen lds
    s_add_u32 s67, s67, 20480
    s_waitcnt lgkmcnt(4)
    v_mfma_f32_32x32x16_bf16 v[16:31], v[60:63], v[64:67], v[16:31]
    s_waitcnt vmcnt(7)
    ds_read_b64_tr_b16 v[48:49], v201 offset:9216
    ds_read_b64_tr_b16 v[50:51], v201 offset:9472
    ds_read_b128 v[52:55], v205 offset:9216
    ds_read_b128 v[56:59], v209 offset:9216
    v_mfma_f32_32x32x16_bf16 v[32:47], v[60:63], v[68:71], v[32:47]
    s_add_u32 m0, s66, 7168
    s_nop 0
    buffer_load_dwordx4 v200, s[12:15], s67 offen lds
    s_add_u32 s67, s67, 20480
    s_waitcnt lgkmcnt(4)
    v_mfma_f32_32x32x16_bf16 v[16:31], v[72:75], v[76:79], v[16:31]
    s_waitcnt vmcnt(7)
    ds_read_b64_tr_b16 v[60:61], v201 offset:0
    ds_read_b64_tr_b16 v[62:63], v201 offset:256
    ds_read_b128 v[64:67], v206 offset:10240
    ds_read_b128 v[68:71], v210 offset:10240
    v_mfma_f32_32x32x16_bf16 v[32:47], v[72:75], v[80:83], v[32:47]
    s_add_u32 m0, s66, 8192
    s_nop 0
    buffer_load_dwordx4 v200, s[12:15], s67 offen lds
    s_add_u32 s67, s67, 20480
    s_waitcnt lgkmcnt(4)
    v_mfma_f32_32x32x16_bf16 v[16:31], v[48:51], v[52:55], v[16:31]
    s_waitcnt vmcnt(7)
    ds_read_b64_tr_b16 v[72:73], v201 offset:1024
    ds_read_b64_tr_b16 v[74:75], v201 offset:1280
    ds_read_b128 v[76:79], v207 offset:11264
    ds_read_b128 v[80:83], v211 offset:11264
    v_mfma_f32_32x32x16_bf16 v[32:47], v[48:51], v[56:59], v[32:47]
    s_add_u32 m0, s66, 9216
    s_nop 0
    buffer_load_dwordx4 v200, s[12:15], s67 offen lds
    s_add_u32 s67, s67, 20480
    s_cmp_eq_u32 s67, 819200
    s_cselect_b32 s67, 0, s67
    s_waitcnt lgkmcnt(4)
    v_mfma_f32_32x32x16_bf16 v[16:31], v[60:63], v[64:67], v[16:31]
    s_waitcnt vmcnt(7)
    ds_read_b64_tr_b16 v[48:49], v201 offset:2048
    ds_read_b64_tr_b16 v[50:51], v201 offset:2304
    s_cmp_eq_u32 s69, 28
    s_cbranch_scc0 L_wrap_7
    v_subrev_u32 v204, 40960, v204
    v_subrev_u32 v208, 40960, v208
    v_subrev_u32 v205, 40960, v205
    v_subrev_u32 v209, 40960, v209
    v_subrev_u32 v206, 40960, v206
    v_subrev_u32 v210, 40960, v210
    v_subrev_u32 v207, 40960, v207
    v_subrev_u32 v211, 40960, v211
L_wrap_7:
    ds_read_b128 v[52:55], v204 offset:12288
    ds_read_b128 v[56:59], v208 offset:12288
    v_mfma_f32_32x32x16_bf16 v[32:47], v[60:63], v[68:71], v[32:47]
    s_add_u32 m0, s66, 0
    s_nop 0
    buffer_load_dwordx4 v200, s[12:15], s67 offen lds
    s_add_u32 s67, s67, 20480
    s_waitcnt lgkmcnt(4)
    v_mfma_f32_32x32x16_bf16 v[16:31], v[72:75], v[76:79], v[16:31]
    s_waitcnt vmcnt(7)
    ds_read_b64_tr_b16 v[60:61], v201 offset:3072
    ds_read_b64_tr_b16 v[62:63], v201 offset:3328
    ds_read_b128 v[64:67], v205 offset:13312
    ds_read_b128 v[68:71], v209 offset:13312
    v_mfma_f32_32x32x16_bf16 v[32:47], v[72:75], v[80:83], v[32:47]
    s_add_u32 m0, s66, 1024
    s_nop 0
    buffer_load_dwordx4 v200, s[12:15], s67 offen lds
    s_add_u32 s67, s67, 20480
    s_waitcnt lgkmcnt(4)
    v_mfma_f32_32x32x16_bf16 v[16:31], v[48:51], v[52:55], v[16:31]
    s_waitcnt vmcnt(7)
    ds_read_b64_tr_b16 v[72:73], v201 offset:4096
    ds_read_b64_tr_b16 v[74:75], v201 offset:4352
    ds_read_b128 v[76:79], v206 offset:14336
    ds_read_b128 v[80:83], v210 offset:14336
    v_mfma_f32_32x32x16_bf16 v[32:47], v[48:51], v[56:59], v[32:47]
    s_add_u32 m0, s66, 2048
    s_nop 0
    buffer_load_dwordx4 v200, s[12:15], s67 offen lds
    s_add_u32 s67, s67, 20480
    s_waitcnt lgkmcnt(4)
    v_mfma_f32_32x32x16_bf16 v[16:31], v[60:63], v[64:67], v[16:31]
    s_waitcnt vmcnt(7)
    ds_read_b64_tr_b16 v[48:49], v201 offset:5120
    ds_read_b64_tr_b16 v[50:51], v201 offset:5376
    ds_read_b128 v[52:55], v207 offset:15360
    ds_read_b128 v[56:59], v211 offset:15360
    v_mfma_f32_32x32x16_bf16 v[32:47], v[60:63], v[68:71], v[32:47]
    s_add_u32 m0, s66, 3072
    s_nop 0
    buffer_load_dwordx4 v200, s[12:15], s67 offen lds
    s_add_u32 s67, s67, 20480
    s_waitcnt lgkmcnt(4)
    v_mfma_f32_32x32x16_bf16 v[16:31], v[72:75], v[76:79], v[16:31]
    s_waitcnt vmcnt(7)
    ds_read_b64_tr_b16 v[60:61], v201 offset:6144
    ds_read_b64_tr_b16 v[62:63], v201 offset:6400
    s_cmp_eq_u32 s69, 24
    s_cbranch_scc0 L_wrap_8
    v_subrev_u32 v204, 40960, v204
    v_subrev_u32 v208, 40960, v208
    v_subrev_u32 v205, 40960, v205
    v_subrev_u32 v209, 40960, v209
    v_subrev_u32 v206, 40960, v206
    v_subrev_u32 v210, 40960, v210
    v_subrev_u32 v207, 40960, v207
    v_subrev_u32 v211, 40960, v211
L_wrap_8:
    ds_read_b128 v[64:67], v204 offset:16384
    ds_read_b128 v[68:71], v208 offset:16384
    v_mfma_f32_32x32x16_bf16 v[32:47], v[72:75], v[80:83], v[32:47]
    s_add_u32 m0, s66, 4096
    s_nop 0
    buffer_load_dwordx4 v200, s[12:15], s67 offen lds
    s_add_u32 s67, s67, 20480
    s_waitcnt lgkmcnt(4)
    v_mfma_f32_32x32x16_bf16 v[16:31], v[48:51], v[52:55], v[16:31]
    s_waitcnt vmcnt(7)
    ds_read_b64_tr_b16 v[72:73], v201 offset:7168
    ds_read_b64_tr_b16 v[74:75], v201 offset:7424
    ds_read_b128 v[76:79], v205 offset:17408
    ds_read_b128 v[80:83], v209 offset:17408
    v_mfma_f32_32x32x16_bf16 v[32:47], v[48:51], v[56:59], v[32:47]
    s_add_u32 m0, s66, 5120
    s_nop 0
    buffer_load_dwordx4 v200, s[12:15], s67 offen lds
    s_add_u32 s67, s67, 20480
    s_waitcnt lgkmcnt(4)
    v_mfma_f32_32x32x16_bf16 v[16:31], v[60:63], v[64:67], v[16:31]
    s_waitcnt vmcnt(7)
    ds_read_b64_tr_b16 v[48:49], v201 offset:8192
    ds_read_b64_tr_b16 v[50:51], v201 offset:8448
    ds_read_b128 v[52:55], v206 offset:18432
    ds_read_b128 v[56:59], v210 offset:18432
    v_mfma_f32_32x32x16_bf16 v[32:47], v[60:63], v[68:71], v[32:47]
    s_add_u32 m0, s66, 6144
    s_nop 0
    buffer_load_dwordx4 v200, s[12:15], s67 offen lds
    s_add_u32 s67, s67, 20480
    s_waitcnt lgkmcnt(4)
    v_mfma_f32_32x32x16_bf16 v[16:31], v[72:75], v[76:79], v[16:31]
    s_waitcnt vmcnt(7)
    ds_read_b64_tr_b16 v[60:61], v201 offset:9216
    ds_read_b64_tr_b16 v[62:63], v201 offset:9472
    ds_read_b128 v[64:67], v207 offset:19456
    ds_read_b128 v[68:71], v211 offset:19456
    v_mfma_f32_32x32x16_bf16 v[32:47], v[72:75], v[80:83], v[32:47]
    s_add_u32 m0, s66, 7168
    s_nop 0
    buffer_load_dwordx4 v200, s[12:15], s67 offen lds
    s_add_u32 s67, s67, 20480
    s_cmp_eq_u32 s67, 819200
    s_cselect_b32 s67, 0, s67
    s_waitcnt lgkmcnt(4)
    v_mfma_f32_32x32x16_bf16 v[16:31], v[48:51], v[52:55], v[16:31]
    s_waitcnt vmcnt(7)
    ds_read_b64_tr_b16 v[72:73], v201 offset:0
    ds_read_b64_tr_b16 v[74:75], v201 offset:256
    s_cmp_eq_u32 s69, 20
    s_cbranch_scc0 L_wrap_9
    v_subrev_u32 v204, 40960, v204
    v_subrev_u32 v208, 40960, v208
    v_subrev_u32 v205, 40960, v205
    v_subrev_u32 v209, 40960, v209
    v_subrev_u32 v206, 40960, v206
    v_subrev_u32 v210, 40960, v210
    v_subrev_u32 v207, 40960, v207
    v_subrev_u32 v211, 40960, v211
L_wrap_9:
    ds_read_b128 v[76:79], v204 offset:20480
    ds_read_b128 v[80:83], v208 offset:20480
    v_mfma_f32_32x32x16_bf16 v[32:47], v[48:51], v[56:59], v[32:47]
    s_add_u32 m0, s66, 8192
    s_nop 0
    buffer_load_dwordx4 v200, s[12:15], s67 offen lds
    s_add_u32 s67, s67, 20480
    s_waitcnt lgkmcnt(4)
    v_mfma_f32_32x32x16_bf16 v[16:31], v[60:63], v[64:67], v[16:31]
    s_waitcnt vmcnt(7)
    ds_read_b64_tr_b16 v[48:49], v201 offset:1024
    ds_read_b64_tr_b16 v[50:51], v201 offset:1280
    ds_read_b128 v[52:55], v205 offset:21504
    ds_read_b128 v[56:59], v209 offset:21504
    v_mfma_f32_32x32x16_bf16 v[32:47], v[60:63], v[68:71], v[32:47]
    s_add_u32 m0, s66, 9216
    s_nop 0
    buffer_load_dwordx4 v200, s[12:15], s67 offen lds
    s_add_u32 s67, s67, 20480
    s_waitcnt lgkmcnt(4)
    v_mfma_f32_32x32x16_bf16 v[16:31], v[72:75], v[76:79], v[16:31]
    s_waitcnt vmcnt(7)
    ds_read_b64_tr_b16 v[60:61], v201 offset:2048
    ds_read_b64_tr_b16 v[62:63], v201 offset:2304
    ds_read_b128 v[64:67], v206 offset:22528
    ds_read_b128 v[68:71], v210 offset:22528
    v_mfma_f32_32x32x16_bf16 v[32:47], v[72:75], v[80:83], v[32:47]
    s_add_u32 m0, s66, 0
    s_nop 0
    buffer_load_dwordx4 v200, s[12:15], s67 offen lds
    s_add_u32 s67, s67, 20480
    s_waitcnt lgkmcnt(4)
    v_mfma_f32_32x32x16_bf16 v[16:31], v[48:51], v[52:55], v[16:31]
    s_waitcnt vmcnt(7)
    ds_read_b64_tr_b16 v[72:73], v201 offset:3072
    ds_read_b64_tr_b16 v[74:75], v201 offset:3328
    ds_read_b128 v[76:79], v207 offset:23552
    ds_read_b128 v[80:83], v211 offset:23552
    v_mfma_f32_32x32x16_bf16 v[32:47], v[48:51], v[56:59], v[32:47]
    s_add_u32 m0, s66, 1024
    s_nop 0
    buffer_load_dwordx4 v200, s[12:15], s67 offen lds
    s_add_u32 s67, s67, 20480
    s_cmp_eq_u32 s67, 819200
    s_cselect_b32 s67, 0, s67
    s_waitcnt lgkmcnt(4)
    v_mfma_f32_32x32x16_bf16 v[16:31], v[60:63], v[64:67], v[16:31]
    s_waitcnt vmcnt(7)
    ds_read_b64_tr_b16 v[48:49], v201 offset:4096
    ds_read_b64_tr_b16 v[50:51], v201 offset:4352
    ds_read_b128 v[52:55], v204 offset:24576
    ds_read_b128 v[56:59], v208 offset:24576
    v_mfma_f32_32x32x16_bf16 v[32:47], v[60:63], v[68:71], v[32:47]
    s_add_u32 m0, s66, 2048
    s_nop 0
    buffer_load_dwordx4 v200, s[12:15], s67 offen lds
    s_add_u32 s67, s67, 20480
    s_waitcnt lgkmcnt(4)
    v_mfma_f32_32x32x16_bf16 v[16:31], v[72:75], v[76:79], v[16:31]
    s_waitcnt vmcnt(7)
    ds_read_b64_tr_b16 v[60:61], v201 offset:5120
    ds_read_b64_tr_b16 v[62:63], v201 offset:5376
    ds_read_b128 v[64:67], v205 offset:25600
    ds_read_b128 v[68:71], v209 offset:25600
    v_mfma_f32_32x32x16_bf16 v[32:47], v[72:75], v[80:83], v[32:47]
    s_add_u32 m0, s66, 3072
    s_nop 0
    buffer_load_dwordx4 v200, s[12:15], s67 offen lds
    s_add_u32 s67, s67, 20480
    s_waitcnt lgkmcnt(4)
    v_mfma_f32_32x32x16_bf16 v[16:31], v[48:51], v[52:55], v[16:31]
    s_waitcnt vmcnt(7)
    ds_read_b64_tr_b16 v[72:73], v201 offset:6144
    ds_read_b64_tr_b16 v[74:75], v201 offset:6400
    ds_read_b128 v[76:79], v206 offset:26624
    ds_read_b128 v[80:83], v210 offset:26624
    v_mfma_f32_32x32x16_bf16 v[32:47], v[48:51], v[56:59], v[32:47]
    s_add_u32 m0, s66, 4096
    s_nop 0
    buffer_load_dwordx4 v200, s[12:15], s67 offen lds
    s_add_u32 s67, s67, 20480
    s_waitcnt lgkmcnt(4)
    v_mfma_f32_32x32x16_bf16 v[16:31], v[60:63], v[64:67], v[16:31]
    s_waitcnt vmcnt(7)
    ds_read_b64_tr_b16 v[48:49], v201 offset:7168
    ds_read_b64_tr_b16 v[50:51], v201 offset:7424
    ds_read_b128 v[52:55], v207 offset:27648
    ds_read_b128 v[56:59], v211 offset:27648
    v_mfma_f32_32x32x16_bf16 v[32:47], v[60:63], v[68:71], v[32:47]
    s_add_u32 m0, s66, 5120
    s_nop 0
    buffer_load_dwordx4 v200, s[12:15], s67 offen lds
    s_add_u32 s67, s67, 20480
    s_cmp_eq_u32 s67, 819200
    s_cselect_b32 s67, 0, s67
    s_waitcnt lgkmcnt(4)
    v_mfma_f32_32x32x16_bf16 v[16:31], v[72:75], v[76:79], v[16:31]
    s_waitcnt vmcnt(7)
    ds_read_b64_tr_b16 v[60:61], v201 offset:8192
    ds_read_b64_tr_b16 v[62:63], v201 offset:8448
    s_cmp_eq_u32 s69, 12
    s_cbranch_scc0 L_wrap_10
    v_subrev_u32 v204, 40960, v204
    v_subrev_u32 v208, 40960, v208
    v_subrev_u32 v205, 40960, v205
    v_subrev_u32 v209, 40960, v209
    v_subrev_u32 v206, 40960, v206
    v_subrev_u32 v210, 40960, v210
    v_subrev_u32 v207, 40960, v207
    v_subrev_u32 v211, 40960, v211
L_wrap_10:
    ds_read_b128 v[64:67], v204 offset:28672
    ds_read_b128 v[68:71], v208 offset:28672
    v_mfma_f32_32x32x16_bf16 v[32:47], v[72:75], v[80:83], v[32:47]
    s_add_u32 m0, s66, 6144
    s_nop 0
    buffer_load_dwordx4 v200, s[12:15], s67 offen lds
    s_add_u32 s67, s67, 20480
    s_waitcnt lgkmcnt(4)
    v_mfma_f32_32x32x16_bf16 v[16:31], v[48:51], v[52:55], v[16:31]
    s_waitcnt vmcnt(7)
    ds_read_b64_tr_b16 v[72:73], v201 offset:9216
    ds_read_b64_tr_b16 v[74:75], v201 offset:9472
    ds_read_b128 v[76:79], v205 offset:29696
    ds_read_b128 v[80:83], v209 offset:29696
    v_mfma_f32_32x32x16_bf16 v[32:47], v[48:51], v[56:59], v[32:47]
    s_add_u32 m0, s66, 7168
    s_nop 0
    buffer_load_dwordx4 v200, s[12:15], s67 offen lds
    s_add_u32 s67, s67, 20480
    s_waitcnt lgkmcnt(4)
    v_mfma_f32_32x32x16_bf16 v[16:31], v[60:63], v[64:67], v[16:31]
    s_waitcnt vmcnt(7)
    ds_read_b64_tr_b16 v[48:49], v201 offset:0
    ds_read_b64_tr_b16 v[50:51], v201 offset:256
    ds_read_b128 v[52:55], v206 offset:30720
    ds_read_b128 v[56:59], v210 offset:30720
    v_mfma_f32_32x32x16_bf16 v[32:47], v[60:63], v[68:71], v[32:47]
    s_add_u32 m0, s66, 8192
    s_nop 0
    buffer_load_dwordx4 v200, s[12:15], s67 offen lds
    s_add_u32 s67, s67, 20480
    s_waitcnt lgkmcnt(4)
    v_mfma_f32_32x32x16_bf16 v[16:31], v[72:75], v[76:79], v[16:31]
    s_waitcnt vmcnt(7)
    ds_read_b64_tr_b16 v[60:61], v201 offset:1024
    ds_read_b64_tr_b16 v[62:63], v201 offset:1280
    ds_read_b128 v[64:67], v207 offset:31744
    ds_read_b128 v[68:71], v211 offset:31744
    v_mfma_f32_32x32x16_bf16 v[32:47], v[72:75], v[80:83], v[32:47]
    s_add_u32 m0, s66, 9216
    s_nop 0
    buffer_load_dwordx4 v200, s[12:15], s67 offen lds
    s_add_u32 s67, s67, 20480
    ds_add_u32 v212, v214 offset:52
    s_waitcnt lgkmcnt(5)
    v_mfma_f32_32x32x16_bf16 v[16:31], v[48:51], v[52:55], v[16:31]
    s_waitcnt vmcnt(7)
    ds_read_b64_tr_b16 v[72:73], v201 offset:2048
    ds_read_b64_tr_b16 v[74:75], v201 offset:2304
    s_cmp_eq_u32 s69, 8
    s_cbranch_scc0 L_wrap_11
    v_subrev_u32 v204, 40960, v204
    v_subrev_u32 v208, 40960, v208
    v_subrev_u32 v205, 40960, v205
    v_subrev_u32 v209, 40960, v209
    v_subrev_u32 v206, 40960, v206
    v_subrev_u32 v210, 40960, v210
    v_subrev_u32 v207, 40960, v207
    v_subrev_u32 v211, 40960, v211
L_wrap_11:
    ds_read_b128 v[76:79], v204 offset:32768
    ds_read_b128 v[80:83], v208 offset:32768
    v_mfma_f32_32x32x16_bf16 v[32:47], v[48:51], v[56:59], v[32:47]
    s_waitcnt lgkmcnt(5)
    v_mfma_f32_32x32x16_bf16 v[16:31], v[60:63], v[64:67], v[16:31]
    s_waitcnt vmcnt(6)
    ds_read_b64_tr_b16 v[48:49], v201 offset:3072
    ds_read_b64_tr_b16 v[50:51], v201 offset:3328
    ds_read_b128 v[52:55], v205 offset:33792
    ds_read_b128 v[56:59], v209 offset:33792
    v_mfma_f32_32x32x16_bf16 v[32:47], v[60:63], v[68:71], v[32:47]
    s_waitcnt lgkmcnt(4)
    v_mfma_f32_32x32x16_bf16 v[16:31], v[72:75], v[76:79], v[16:31]
    s_waitcnt vmcnt(5)
    ds_read_b64_tr_b16 v[60:61], v201 offset:4096
    ds_read_b64_tr_b16 v[62:63], v201 offset:4352
    ds_read_b128 v[64:67], v206 offset:34816
    ds_read_b128 v[68:71], v210 offset:34816
    v_mfma_f32_32x32x16_bf16 v[32:47], v[72:75], v[80:83], v[32:47]
    s_waitcnt lgkmcnt(4)
    v_mfma_f32_32x32x16_bf16 v[16:31], v[48:51], v[52:55], v[16:31]
    s_waitcnt vmcnt(4)
    ds_read_b64_tr_b16 v[72:73], v201 offset:5120
    ds_read_b64_tr_b16 v[74:75], v201 offset:5376
    ds_read_b128 v[76:79], v207 offset:35840
    ds_read_b128 v[80:83], v211 offset:35840
    v_mfma_f32_32x32x16_bf16 v[32:47], v[48:51], v[56:59], v[32:47]
    s_waitcnt lgkmcnt(4)
    v_mfma_f32_32x32x16_bf16 v[16:31], v[60:63], v[64:67], v[16:31]
    s_waitcnt vmcnt(3)
    ds_read_b64_tr_b16 v[48:49], v201 offset:6144
    ds_read_b64_tr_b16 v[50:51], v201 offset:6400
    s_cmp_eq_u32 s69, 4
    s_cbranch_scc0 L_wrap_12
    v_subrev_u32 v204, 40960, v204
    v_subrev_u32 v208, 40960, v208
    v_subrev_u32 v205, 40960, v205
    v_subrev_u32 v209, 40960, v209
    v_subrev_u32 v206, 40960, v206
    v_subrev_u32 v210, 40960, v210
    v_subrev_u32 v207, 40960, v207
    v_subrev_u32 v211, 40960, v211
L_wrap_12:
    ds_read_b128 v[52:55], v204 offset:36864
    ds_read_b128 v[56:59], v208 offset:36864
    v_mfma_f32_32x32x16_bf16 v[32:47], v[60:63], v[68:71], v[32:47]
    s_waitcnt lgkmcnt(4)
    v_mfma_f32_32x32x16_bf16 v[16:31], v[72:75], v[76:79], v[16:31]
    s_waitcnt vmcnt(2)
    ds_read_b64_tr_b16 v[60:61], v201 offset:7168
    ds_read_b64_tr_b16 v[62:63], v201 offset:7424
    ds_read_b128 v[64:67], v205 offset:37888
    ds_read_b128 v[68:71], v209 offset:37888
    v_mfma_f32_32x32x16_bf16 v[32:47], v[72:75], v[80:83], v[32:47]
    s_waitcnt lgkmcnt(4)
    v_mfma_f32_32x32x16_bf16 v[16:31], v[48:51], v[52:55], v[16:31]
    s_waitcnt vmcnt(1)
    ds_read_b64_tr_b16 v[72:73], v201 offset:8192
    ds_read_b64_tr_b16 v[74:75], v201 offset:8448
    ds_read_b128 v[76:79], v206 offset:38912
    ds_read_b128 v[80:83], v210 offset:38912
    v_mfma_f32_32x32x16_bf16 v[32:47], v[48:51], v[56:59], v[32:47]
    s_waitcnt lgkmcnt(4)
    v_mfma_f32_32x32x16_bf16 v[16:31], v[60:63], v[64:67], v[16:31]
    s_waitcnt vmcnt(0)
    ds_read_b64_tr_b16 v[48:49], v201 offset:9216
    ds_read_b64_tr_b16 v[50:51], v201 offset:9472
    ds_read_b128 v[52:55], v207 offset:39936
    ds_read_b128 v[56:59], v211 offset:39936
    v_mfma_f32_32x32x16_bf16 v[32:47], v[60:63], v[68:71], v[32:47]
    s_waitcnt lgkmcnt(4)
    v_mfma_f32_32x32x16_bf16 v[16:31], v[72:75], v[76:79], v[16:31]
    v_mfma_f32_32x32x16_bf16 v[32:47], v[72:75], v[80:83], v[32:47]
    s_waitcnt lgkmcnt(0)
    v_mfma_f32_32x32x16_bf16 v[16:31], v[48:51], v[52:55], v[16:31]
    v_mfma_f32_32x32x16_bf16 v[32:47], v[48:51], v[56:59], v[32:47]
    ds_add_u32 v212, v214 offset:20
    ds_add_u32 v212, v214 offset:12
    v_cmp_gt_u32 vcc, 32, v0
    v_mov_b32 v216, 0x3ea52b5c
    v_mov_b32 v217, 0
    s_nop 6
    v_cndmask_b32 v217, v217, v216, vcc
    v_mul_f32 v16, v216, v16
    v_mul_f32 v17, v216, v17
    v_mul_f32 v18, v216, v18
    v_mul_f32 v19, v216, v19
    v_mul_f32 v20, v216, v20
    v_mul_f32 v21, v216, v21
    v_mul_f32 v22, v216, v22
    v_mul_f32 v23, v216, v23
    v_mul_f32 v24, v217, v24
    v_mul_f32 v25, v217, v25
    v_mul_f32 v26, v217, v26
    v_mul_f32 v27, v217, v27
    v_cvt_pk_bf16_f32 v128, v16, v17
    v_cvt_pk_bf16_f32 v129, v18, v19
    v_cvt_pk_bf16_f32 v130, v20, v21
    v_cvt_pk_bf16_f32 v131, v22, v23
    v_cvt_pk_bf16_f32 v136, v24, v25
    v_cvt_pk_bf16_f32 v137, v26, v27
    v_mul_f32 v182, v16, v16
    v_fmac_f32 v182, v17, v17
    v_fmac_f32 v182, v18, v18
    v_fmac_f32 v182, v19, v19
    v_fmac_f32 v182, v20, v20
    v_fmac_f32 v182, v21, v21
    v_fmac_f32 v182, v22, v22
    v_fmac_f32 v182, v23, v23
    v_fmac_f32 v182, v24, v24
    v_fmac_f32 v182, v25, v25
    v_fmac_f32 v182, v26, v26
    v_fmac_f32 v182, v27, v27
    v_mul_f32 v32, v216, v32
    v_mul_f32 v33, v216, v33
    v_mul_f32 v34, v216, v34
    v_mul_f32 v35, v216, v35
    v_mul_f32 v36, v216, v36
    v_mul_f32 v37, v216, v37
    v_mul_f32 v38, v216, v38
    v_mul_f32 v39, v216, v39
    v_mul_f32 v40, v217, v40
    v_mul_f32 v41, v217, v41
    v_mul_f32 v42, v217, v42
    v_mul_f32 v43, v217, v43
    v_cvt_pk_bf16_f32 v132, v32, v33
    v_cvt_pk_bf16_f32 v133, v34, v35
    v_cvt_pk_bf16_f32 v134, v36, v37
    v_cvt_pk_bf16_f32 v135, v38, v39
    v_cvt_pk_bf16_f32 v138, v40, v41
    v_cvt_pk_bf16_f32 v139, v42, v43
    v_mul_f32 v183, v32, v32
    v_fmac_f32 v183, v33, v33
    v_fmac_f32 v183, v34, v34
    v_fmac_f32 v183, v35, v35
    v_fmac_f32 v183, v36, v36
    v_fmac_f32 v183, v37, v37
    v_fmac_f32 v183, v38, v38
    v_fmac_f32 v183, v39, v39
    v_fmac_f32 v183, v40, v40
    v_fmac_f32 v183, v41, v41
    v_fmac_f32 v183, v42, v42
    v_fmac_f32 v183, v43, v43
    v_mov_b32 v218, v182
    v_mov_b32 v219, v183
    s_nop 0
    v_permlane32_swap_b32 v182, v218
    v_permlane32_swap_b32 v183, v219
    s_nop 0
    v_add_f32 v182, v182, v218
    v_add_f32 v183, v183, v219
    v_mov_b32 v48, 0
    v_mov_b32 v49, 0
    v_mov_b32 v50, 0
    v_mov_b32 v51, 0
    v_mov_b32 v52, 0
    v_mov_b32 v53, 0
    v_mov_b32 v54, 0
    v_mov_b32 v55, 0
    v_mov_b32 v56, 0
    v_mov_b32 v57, 0
    v_mov_b32 v58, 0
    v_mov_b32 v59, 0
    v_mov_b32 v60, 0
    v_mov_b32 v61, 0
    v_mov_b32 v62, 0
    v_mov_b32 v63, 0
    v_mov_b32 v64, 0
    v_mov_b32 v65, 0
    v_mov_b32 v66, 0
    v_mov_b32 v67, 0
    v_mov_b32 v68, 0
    v_mov_b32 v69, 0
    v_mov_b32 v70, 0
    v_mov_b32 v71, 0
    v_mov_b32 v72, 0
    v_mov_b32 v73, 0
    v_mov_b32 v74, 0
    v_mov_b32 v75, 0
    v_mov_b32 v76, 0
    v_mov_b32 v77, 0
    v_mov_b32 v78, 0
    v_mov_b32 v79, 0
    v_mov_b32 v88, 0
    v_mov_b32 v89, 0
    v_mov_b32 v90, 0
    v_mov_b32 v91, 0
    v_mov_b32 v92, 0
    v_mov_b32 v93, 0
    v_mov_b32 v94, 0
    v_mov_b32 v95, 0
    v_mov_b32 v164, 0
    v_mov_b32 v165, 0
    v_mov_b32 v166, 0
    v_mov_b32 v167, 0
    v_mov_b32 v168, 0
    v_mov_b32 v169, 0
    v_mov_b32 v170, 0
    v_mov_b32 v171, 0
    s_lshl_b32 s62, s4, 1
    s_mul_i32 s62, s62, 40960
    s_add_u32 s80, s62, 8388608
    s_mul_i32 s63, s5, 5
    s_add_u32 s81, s63, s7
    s_lshl_b32 s81, s81, 10
    s_add_u32 s63, s63, 4
    s_lshl_b32 s63, s63, 10
    s_lshr_b32 s65, s7, 1
    s_lshl_b32 s65, s65, 9
    s_add_u32 s63, s63, s65
    s_and_b32 s65, s7, 1
    s_lshl_b32 s65, s65, 3
    s_add_u32 s82, s63, s65
    s_setprio 2
    s_cmp_lg_u32 s7, 0
    s_cbranch_scc1 L_kvw_13
    v_lshlrev_b32 v216, 2, v0
    s_lshl_b32 s63, s4, 8
    s_add_u32 s63, s63, 4096
    s_mov_b32 s62, 0
L_poll_15:
    buffer_load_dword v217, v216, s[36:39], s63 offen sc1
    s_waitcnt vmcnt(0)
    v_cmp_ne_u32 vcc, s6, v217
    s_cbranch_vccz L_polld_16
    s_add_u32 s62, s62, 1
    s_cmp_lt_u32 s62, 40000
    s_sleep 2
    s_cbranch_scc1 L_poll_15
L_polld_16:
    ds_add_u32 v212, v214 offset:16
    s_branch L_kvj_14
L_kvw_13:
    s_mov_b32 s62, 0
L_spin_17:
    ds_read_b32 v218, v213 offset:16
    s_waitcnt lgkmcnt(0)
    v_cmp_gt_u32 vcc, 1, v218
    s_cbranch_vccz L_spind_18
    s_add_u32 s62, s62, 1
    s_cmp_lt_u32 s62, 400000
    s_cbranch_scc1 L_spin_17
L_spind_18:
L_kvj_14:
    s_waitcnt lgkmcnt(0)
    v_lshlrev_b32 v216, 2, v0
    s_mov_b32 s62, 32768
    buffer_load_dword v184, v216, s[36:39], s62 offen sc1
    s_mov_b32 s63, 33792
    buffer_load_dword v186, v216, s[36:39], s63 offen sc1
    s_mov_b32 s62, 0
L_spin_19:
    ds_read_b32 v218, v213 offset:12
    s_waitcnt lgkmcnt(0)
    v_cmp_gt_u32 vcc, 4, v218
    s_cbranch_vccz L_spind_20
    s_add_u32 s62, s62, 1
    s_cmp_lt_u32 s62, 400000
    s_cbranch_scc1 L_spin_19
L_spind_20:
    s_add_u32 m0, s72, 0
    s_add_u32 s73, s79, 12288
    buffer_load_dwordx4 v181, s[36:39], s79 offen offset:0 sc1 lds
    buffer_load_dwordx4 v181, s[36:39], s79 offen offset:1024 sc1 lds
    buffer_load_dwordx4 v181, s[36:39], s79 offen offset:2048 sc1 lds
    s_cmp_eq_u32 s73, 262144
    s_cselect_b32 s79, 65536, s73
    s_add_u32 m0, s72, 11136
    s_add_u32 s73, s79, 12288
    buffer_load_dwordx4 v181, s[36:39], s79 offen offset:0 sc1 lds
    buffer_load_dwordx4 v181, s[36:39], s79 offen offset:1024 sc1 lds
    buffer_load_dwordx4 v181, s[36:39], s79 offen offset:2048 sc1 lds
    s_cmp_eq_u32 s73, 262144
    s_cselect_b32 s79, 65536, s73
    s_add_u32 m0, s72, 22272
    s_add_u32 s73, s79, 12288
    buffer_load_dwordx4 v181, s[36:39], s79 offen offset:0 sc1 lds
    buffer_load_dwordx4 v181, s[36:39], s79 offen offset:1024 sc1 lds
    buffer_load_dwordx4 v181, s[36:39], s79 offen offset:2048 sc1 lds
    s_cmp_eq_u32 s73, 262144
    s_cselect_b32 s79, 65536, s73
    ds_add_u32 v212, v214 offset:36
    s_waitcnt vmcnt(9)
    s_nop 0
    v_max_f32_dpp v184, v184, v184 row_shr:1 row_mask:0xf bank_mask:0xf
    v_max_f32_dpp v186, v186, v186 row_shr:1 row_mask:0xf bank_mask:0xf
    s_nop 0
    v_max_f32_dpp v184, v184, v184 row_shr:2 row_mask:0xf bank_mask:0xf
    v_max_f32_dpp v186, v186, v186 row_shr:2 row_mask:0xf bank_mask:0xf
    s_nop 0
    v_max_f32_dpp v184, v184, v184 row_shr:4 row_mask:0xf bank_mask:0xf
    v_max_f32_dpp v186, v186, v186 row_shr:4 row_mask:0xf bank_mask:0xf
    s_nop 0
    v_max_f32_dpp v184, v184, v184 row_shr:8 row_mask:0xf bank_mask:0xf
    v_max_f32_dpp v186, v186, v186 row_shr:8 row_mask:0xf bank_mask:0xf
    s_nop 0
    v_max_f32_dpp v184, v184, v184 row_bcast:15 row_mask:0xa bank_mask:0xf
    v_max_f32_dpp v186, v186, v186 row_bcast:15 row_mask:0xa bank_mask:0xf
    s_nop 0
    v_max_f32_dpp v184, v184, v184 row_bcast:31 row_mask:0xc bank_mask:0xf
    v_max_f32_dpp v186, v186, v186 row_bcast:31 row_mask:0xc bank_mask:0xf
    s_nop 0
    v_readlane_b32 s62, v184, 63
    v_readlane_b32 s64, v186, 63
    s_nop 0
    v_mov_b32 v184, s62
    v_mov_b32 v186, s64
    v_max_f32 v186, 1.0, v186
    v_log_f32 v186, v186
    v_mov_b32 v185, 0x42620000
    v_mul_f32 v182, v182, v184
    v_mul_f32 v183, v183, v184
    v_fma_f32 v186, v186, -0.5, v185
    v_sqrt_f32 v182, v182
    v_sqrt_f32 v183, v183
    s_nop 0
    v_mul_f32 v182, 0x3f828f5c, v182
    v_mul_f32 v183, 0x3f828f5c, v183
    v_cmp_nle_f32 vcc, v182, v186
    v_cmp_nle_f32 s[64:65], v183, v186
    s_nop 0
    s_or_b64 vcc, vcc, s[64:65]
    s_cbranch_vccz L_safe_21
    v_mov_b32 v96, 0
    v_mov_b32 v97, 0
    v_mov_b32 v98, 0
    v_mov_b32 v99, 0
    v_mov_b32 v100, 0
    v_mov_b32 v101, 0
    v_mov_b32 v102, 0
    v_mov_b32 v103, 0
    v_mov_b32 v104, 0
    v_mov_b32 v105, 0
    v_mov_b32 v106, 0
    v_mov_b32 v107, 0
    v_mov_b32 v108, 0
    v_mov_b32 v109, 0
    v_mov_b32 v110, 0
    v_mov_b32 v111, 0
    v_mov_b32 v182, 0xff800000
    v_mov_b32 v112, 0
    v_mov_b32 v113, 0
    v_mov_b32 v114, 0
    v_mov_b32 v115, 0
    v_mov_b32 v116, 0
    v_mov_b32 v117, 0
    v_mov_b32 v118, 0
    v_mov_b32 v119, 0
    v_mov_b32 v120, 0
    v_mov_b32 v121, 0
    v_mov_b32 v122, 0
    v_mov_b32 v123, 0
    v_mov_b32 v124, 0
    v_mov_b32 v125, 0
    v_mov_b32 v126, 0
    v_mov_b32 v127, 0
    v_mov_b32 v183, 0xff800000
    v_and_b32 v216, 31, v0
    v_lshlrev_b32 v216, 4, v216
    s_mov_b32 s64, 0
L_tm_22:
    s_lshr_b32 s62, s64, 2
    s_mul_i32 s62, s62, 12288
    s_add_u32 s62, s62, 65536
    s_and_b32 s63, s64, 3
    s_lshl_b32 s65, s63, 10
    s_add_u32 s65, s65, s62
    buffer_load_dwordx4 v[140:143], v215, s[36:39], s65 offen sc1
    s_lshr_b32 s65, s63, 1
    s_lshl_b32 s65, s65, 9
    s_and_b32 s63, s63, 1
    s_lshl_b32 s63, s63, 3
    s_add_u32 s65, s65, s63
    s_add_u32 s65, s65, s62
    s_add_u32 s65, s65, 4096
    buffer_load_dwordx2 v[148:149], v216, s[36:39], s65 offen sc1
    s_waitcnt vmcnt(0)
    v_mfma_f32_32x32x16_bf16 v[16:31], v[140:143], v[128:131], v[96:111]
    v_mfma_f32_32x32x8_bf16 v[16:31], v[148:149], v[136:137], v[16:31]
    v_mfma_f32_32x32x16_bf16 v[32:47], v[140:143], v[132:135], v[112:127]
    v_mfma_f32_32x32x8_bf16 v[32:47], v[148:149], v[138:139], v[32:47]
    s_nop 11
    v_max3_f32 v182, v182, v16, v17
    v_max3_f32 v182, v182, v18, v19
    v_max3_f32 v182, v182, v20, v21
    v_max3_f32 v182, v182, v22, v23
    v_max3_f32 v182, v182, v24, v25
    v_max3_f32 v182, v182, v26, v27
    v_max3_f32 v182, v182, v28, v29
    v_max3_f32 v182, v182, v30, v31
    v_max3_f32 v183, v183, v32, v33
    v_max3_f32 v183, v183, v34, v35
    v_max3_f32 v183, v183, v36, v37
    v_max3_f32 v183, v183, v38, v39
    v_max3_f32 v183, v183, v40, v41
    v_max3_f32 v183, v183, v42, v43
    v_max3_f32 v183, v183, v44, v45
    v_max3_f32 v183, v183, v46, v47
    s_add_u32 s64, s64, 1
    s_cmp_lt_u32 s64, 64
    s_cbranch_scc1 L_tm_22
    v_mov_b32 v218, v182
    v_mov_b32 v219, v183
    s_nop 0
    v_permlane32_swap_b32 v182, v218
    v_permlane32_swap_b32 v183, v219
    s_nop 0
    v_max_f32 v182, v182, v218
    v_max_f32 v183, v183, v219
    v_sub_f32 v182, 0, v182
    v_sub_f32 v183, 0, v183
L_safe_21:
    v_mov_b32 v96, v182
    v_mov_b32 v97, v182
    v_mov_b32 v98, v182
    v_mov_b32 v99, v182
    v_mov_b32 v100, v182
    v_mov_b32 v101, v182
    v_mov_b32 v102, v182
    v_mov_b32 v103, v182
    v_mov_b32 v104, v182
    v_mov_b32 v105, v182
    v_mov_b32 v106, v182
    v_mov_b32 v107, v182
    v_mov_b32 v108, v182
    v_mov_b32 v109, v182
    v_mov_b32 v110, v182
    v_mov_b32 v111, v182
    v_mov_b32 v112, v183
    v_mov_b32 v113, v183
    v_mov_b32 v114, v183
    v_mov_b32 v115, v183
    v_mov_b32 v116, v183
    v_mov_b32 v117, v183
    v_mov_b32 v118, v183
    v_mov_b32 v119, v183
    v_mov_b32 v120, v183
    v_mov_b32 v121, v183
    v_mov_b32 v122, v183
    v_mov_b32 v123, v183
    v_mov_b32 v124, v183
    v_mov_b32 v125, v183
    v_mov_b32 v126, v183
    v_mov_b32 v127, v183
    s_waitcnt vmcnt(6)
    ds_add_u32 v212, v214 offset:0
    s_mov_b32 s62, 0
L_spin_23:
    ds_read_b32 v180, v213 offset:0
    s_waitcnt lgkmcnt(0)
    v_cmp_gt_u32 vcc, 4, v180
    s_cbranch_vccz L_spind_24
    s_add_u32 s62, s62, 1
    s_cmp_lt_u32 s62, 400000
    s_cbranch_scc1 L_spin_23
L_spind_24:
    s_mov_b32 s74, 0
    s_mov_b32 s78, 8
    ds_read_b128 v[140:143], v172
    ds_read_b128 v[148:151], v173
    s_waitcnt lgkmcnt(0)
    v_mfma_f32_32x32x16_bf16 v[16:31], v[140:143], v[128:131], v[96:111]
    v_mfma_f32_32x32x8_bf16 v[16:31], v[148:149], v[136:137], v[16:31]
    s_nop 8
.p2align 6
L_ATT:
    s_waitcnt vmcnt(3)
    ds_add_u32 v212, v214 offset:0
    v_mfma_f32_32x32x16_bf16 v[32:47], v[140:143], v[132:135], v[112:127]
    ds_read_b128 v[144:147], v172 offset:1024
    v_exp_f32 v16, v16
    v_exp_f32 v17, v17
    v_exp_f32 v18, v18
    v_exp_f32 v19, v19
    v_cvt_pk_bf16_f32 v80, v16, v17
    v_cvt_pk_bf16_f32 v81, v18, v19
    v_mfma_f32_32x32x8_bf16 v[32:47], v[148:149], v[138:139], v[32:47]
    ds_read_b128 v[156:159], v174 offset:0
    v_exp_f32 v20, v20
    v_exp_f32 v21, v21
    v_exp_f32 v22, v22
    v_exp_f32 v23, v23
    v_cvt_pk_bf16_f32 v82, v20, v21
    v_cvt_pk_bf16_f32 v83, v22, v23
    v_mfma_f32_32x32x16_bf16 v[64:79], v[164:167], v[88:91], v[64:79]
    ds_read_b128 v[160:163], v174 offset:704
    v_exp_f32 v24, v24
    v_exp_f32 v25, v25
    v_exp_f32 v26, v26
    v_exp_f32 v27, v27
    v_cvt_pk_bf16_f32 v84, v24, v25
    v_cvt_pk_bf16_f32 v85, v26, v27
    v_mfma_f32_32x32x16_bf16 v[64:79], v[168:171], v[92:95], v[64:79]
    v_exp_f32 v28, v28
    v_exp_f32 v29, v29
    v_exp_f32 v30, v30
    v_exp_f32 v31, v31
    v_cvt_pk_bf16_f32 v86, v28, v29
    v_cvt_pk_bf16_f32 v87, v30, v31
    s_waitcnt lgkmcnt(2)
    v_mfma_f32_32x32x16_bf16 v[16:31], v[144:147], v[128:131], v[96:111]
    v_exp_f32 v32, v32
    v_exp_f32 v33, v33
    v_exp_f32 v34, v34
    v_exp_f32 v35, v35
    v_cvt_pk_bf16_f32 v88, v32, v33
    v_cvt_pk_bf16_f32 v89, v34, v35
    v_mfma_f32_32x32x8_bf16 v[16:31], v[150:151], v[136:137], v[16:31]
    v_exp_f32 v36, v36
    v_exp_f32 v37, v37
    v_exp_f32 v38, v38
    v_exp_f32 v39, v39
    v_cvt_pk_bf16_f32 v90, v36, v37
    v_cvt_pk_bf16_f32 v91, v38, v39
    s_waitcnt lgkmcnt(0)
    v_mfma_f32_32x32x16_bf16 v[48:63], v[156:159], v[80:83], v[48:63]
    v_exp_f32 v40, v40
    v_exp_f32 v41, v41
    v_exp_f32 v42, v42
    v_exp_f32 v43, v43
    v_cvt_pk_bf16_f32 v92, v40, v41
    v_cvt_pk_bf16_f32 v93, v42, v43
    v_mfma_f32_32x32x16_bf16 v[48:63], v[160:163], v[84:87], v[48:63]
    ds_read_b32 v180, v213 offset:0
    v_exp_f32 v44, v44
    v_exp_f32 v45, v45
    v_exp_f32 v46, v46
    v_exp_f32 v47, v47
    v_cvt_pk_bf16_f32 v94, v44, v45
    v_cvt_pk_bf16_f32 v95, v46, v47
    v_mfma_f32_32x32x16_bf16 v[32:47], v[144:147], v[132:135], v[112:127]
    ds_read_b128 v[140:143], v172 offset:2048
    v_exp_f32 v16, v16
    v_exp_f32 v17, v17
    v_exp_f32 v18, v18
    v_exp_f32 v19, v19
    v_cvt_pk_bf16_f32 v80, v16, v17
    v_cvt_pk_bf16_f32 v81, v18, v19
    v_mfma_f32_32x32x8_bf16 v[32:47], v[150:151], v[138:139], v[32:47]
    ds_read_b128 v[152:155], v173 offset:512
    v_exp_f32 v20, v20
    v_exp_f32 v21, v21
    v_exp_f32 v22, v22
    v_exp_f32 v23, v23
    v_cvt_pk_bf16_f32 v82, v20, v21
    v_cvt_pk_bf16_f32 v83, v22, v23
    v_mfma_f32_32x32x16_bf16 v[64:79], v[156:159], v[88:91], v[64:79]
    ds_read_b128 v[164:167], v174 offset:1408
    v_exp_f32 v24, v24
    v_exp_f32 v25, v25
    v_exp_f32 v26, v26
    v_exp_f32 v27, v27
    v_cvt_pk_bf16_f32 v84, v24, v25
    v_cvt_pk_bf16_f32 v85, v26, v27
    v_mfma_f32_32x32x16_bf16 v[64:79], v[160:163], v[92:95], v[64:79]
    ds_read_b128 v[168:171], v174 offset:2112
    v_exp_f32 v28, v28
    v_exp_f32 v29, v29
    v_exp_f32 v30, v30
    v_exp_f32 v31, v31
    v_cvt_pk_bf16_f32 v86, v28, v29
    v_cvt_pk_bf16_f32 v87, v30, v31
    s_waitcnt lgkmcnt(2)
    v_mfma_f32_32x32x16_bf16 v[16:31], v[140:143], v[128:131], v[96:111]
    v_cmp_gt_u32 vcc, s78, v180
    s_cbranch_vccz L_arr_25
    s_mov_b32 s62, 0
L_spin_26:
    ds_read_b32 v180, v213 offset:0
    s_waitcnt lgkmcnt(0)
    v_cmp_gt_u32 vcc, s78, v180
    s_cbranch_vccz L_spind_27
    s_add_u32 s62, s62, 1
    s_cmp_lt_u32 s62, 400000
    s_cbranch_scc1 L_spin_26
L_spind_27:
L_arr_25:
    v_exp_f32 v32, v32
    v_exp_f32 v33, v33
    v_exp_f32 v34, v34
    v_exp_f32 v35, v35
    v_cvt_pk_bf16_f32 v88, v32, v33
    v_cvt_pk_bf16_f32 v89, v34, v35
    v_mfma_f32_32x32x8_bf16 v[16:31], v[152:153], v[136:137], v[16:31]
    s_add_u32 m0, s72, 33408
    s_add_u32 s73, s79, 12288
    buffer_load_dwordx4 v181, s[36:39], s79 offen offset:0 sc1 lds
    buffer_load_dwordx4 v181, s[36:39], s79 offen offset:1024 sc1 lds
    buffer_load_dwordx4 v181, s[36:39], s79 offen offset:2048 sc1 lds
    s_cmp_eq_u32 s73, 262144
    s_cselect_b32 s79, 65536, s73
    s_add_u32 s78, s78, 4
    v_exp_f32 v36, v36
    v_exp_f32 v37, v37
    v_exp_f32 v38, v38
    v_exp_f32 v39, v39
    v_cvt_pk_bf16_f32 v90, v36, v37
    v_cvt_pk_bf16_f32 v91, v38, v39
    s_waitcnt lgkmcnt(0)
    v_mfma_f32_32x32x16_bf16 v[48:63], v[164:167], v[80:83], v[48:63]
    v_exp_f32 v40, v40
    v_exp_f32 v41, v41
    v_exp_f32 v42, v42
    v_exp_f32 v43, v43
    v_cvt_pk_bf16_f32 v92, v40, v41
    v_cvt_pk_bf16_f32 v93, v42, v43
    v_mfma_f32_32x32x16_bf16 v[48:63], v[168:171], v[84:87], v[48:63]
    v_exp_f32 v44, v44
    v_exp_f32 v45, v45
    v_exp_f32 v46, v46
    v_exp_f32 v47, v47
    v_cvt_pk_bf16_f32 v94, v44, v45
    v_cvt_pk_bf16_f32 v95, v46, v47
    v_mfma_f32_32x32x16_bf16 v[32:47], v[140:143], v[132:135], v[112:127]
    ds_read_b128 v[144:147], v172 offset:3072
    v_exp_f32 v16, v16
    v_exp_f32 v17, v17
    v_exp_f32 v18, v18
    v_exp_f32 v19, v19
    v_cvt_pk_bf16_f32 v80, v16, v17
    v_cvt_pk_bf16_f32 v81, v18, v19
    v_mfma_f32_32x32x8_bf16 v[32:47], v[152:153], v[138:139], v[32:47]
    ds_read_b128 v[156:159], v174 offset:2816
    v_exp_f32 v20, v20
    v_exp_f32 v21, v21
    v_exp_f32 v22, v22
    v_exp_f32 v23, v23
    v_cvt_pk_bf16_f32 v82, v20, v21
    v_cvt_pk_bf16_f32 v83, v22, v23
    v_mfma_f32_32x32x16_bf16 v[64:79], v[164:167], v[88:91], v[64:79]
    ds_read_b128 v[160:163], v174 offset:3520
    v_exp_f32 v24, v24
    v_exp_f32 v25, v25
    v_exp_f32 v26, v26
    v_exp_f32 v27, v27
    v_cvt_pk_bf16_f32 v84, v24, v25
    v_cvt_pk_bf16_f32 v85, v26, v27
    v_mfma_f32_32x32x16_bf16 v[64:79], v[168:171], v[92:95], v[64:79]
    v_exp_f32 v28, v28
    v_exp_f32 v29, v29
    v_exp_f32 v30, v30
    v_exp_f32 v31, v31
    v_cvt_pk_bf16_f32 v86, v28, v29
    v_cvt_pk_bf16_f32 v87, v30, v31
    s_waitcnt lgkmcnt(2)
    v_mfma_f32_32x32x16_bf16 v[16:31], v[144:147], v[128:131], v[96:111]
    v_exp_f32 v32, v32
    v_exp_f32 v33, v33
    v_exp_f32 v34, v34
    v_exp_f32 v35, v35
    v_cvt_pk_bf16_f32 v88, v32, v33
    v_cvt_pk_bf16_f32 v89, v34, v35
    v_mfma_f32_32x32x8_bf16 v[16:31], v[154:155], v[136:137], v[16:31]
    v_exp_f32 v36, v36
    v_exp_f32 v37, v37
    v_exp_f32 v38, v38
    v_exp_f32 v39, v39
    v_cvt_pk_bf16_f32 v90, v36, v37
    v_cvt_pk_bf16_f32 v91, v38, v39
    s_waitcnt lgkmcnt(0)
    v_mfma_f32_32x32x16_bf16 v[48:63], v[156:159], v[80:83], v[48:63]
    v_exp_f32 v40, v40
    v_exp_f32 v41, v41
    v_exp_f32 v42, v42
    v_exp_f32 v43, v43
    v_cvt_pk_bf16_f32 v92, v40, v41
    v_cvt_pk_bf16_f32 v93, v42, v43
    v_mfma_f32_32x32x16_bf16 v[48:63], v[160:163], v[84:87], v[48:63]
    v_exp_f32 v44, v44
    v_exp_f32 v45, v45
    v_exp_f32 v46, v46
    v_exp_f32 v47, v47
    v_cvt_pk_bf16_f32 v94, v44, v45
    v_cvt_pk_bf16_f32 v95, v46, v47
    v_mfma_f32_32x32x16_bf16 v[32:47], v[144:147], v[132:135], v[112:127]
    ds_read_b128 v[140:143], v172 offset:11136
    v_exp_f32 v16, v16
    v_exp_f32 v17, v17
    v_exp_f32 v18, v18
    v_exp_f32 v19, v19
    v_cvt_pk_bf16_f32 v80, v16, v17
    v_cvt_pk_bf16_f32 v81, v18, v19
    v_mfma_f32_32x32x8_bf16 v[32:47], v[154:155], v[138:139], v[32:47]
    ds_read_b128 v[148:151], v173 offset:11136
    v_exp_f32 v20, v20
    v_exp_f32 v21, v21
    v_exp_f32 v22, v22
    v_exp_f32 v23, v23
    v_cvt_pk_bf16_f32 v82, v20, v21
    v_cvt_pk_bf16_f32 v83, v22, v23
    v_mfma_f32_32x32x16_bf16 v[64:79], v[156:159], v[88:91], v[64:79]
    ds_read_b128 v[164:167], v174 offset:4224
    v_exp_f32 v24, v24
    v_exp_f32 v25, v25
    v_exp_f32 v26, v26
    v_exp_f32 v27, v27
    v_cvt_pk_bf16_f32 v84, v24, v25
    v_cvt_pk_bf16_f32 v85, v26, v27
    v_mfma_f32_32x32x16_bf16 v[64:79], v[160:163], v[92:95], v[64:79]
    ds_read_b128 v[168:171], v174 offset:4928
    v_exp_f32 v28, v28
    v_exp_f32 v29, v29
    v_exp_f32 v30, v30
    v_exp_f32 v31, v31
    v_cvt_pk_bf16_f32 v86, v28, v29
    v_cvt_pk_bf16_f32 v87, v30, v31
    s_waitcnt lgkmcnt(2)
    v_mfma_f32_32x32x16_bf16 v[16:31], v[140:143], v[128:131], v[96:111]
    v_exp_f32 v32, v32
    v_exp_f32 v33, v33
    v_exp_f32 v34, v34
    v_exp_f32 v35, v35
    v_cvt_pk_bf16_f32 v88, v32, v33
    v_cvt_pk_bf16_f32 v89, v34, v35
    v_mfma_f32_32x32x8_bf16 v[16:31], v[148:149], v[136:137], v[16:31]
    v_exp_f32 v36, v36
    v_exp_f32 v37, v37
    v_exp_f32 v38, v38
    v_exp_f32 v39, v39
    v_cvt_pk_bf16_f32 v90, v36, v37
    v_cvt_pk_bf16_f32 v91, v38, v39
    s_waitcnt lgkmcnt(0)
    v_mfma_f32_32x32x16_bf16 v[48:63], v[164:167], v[80:83], v[48:63]
    v_exp_f32 v40, v40
    v_exp_f32 v41, v41
    v_exp_f32 v42, v42
    v_exp_f32 v43, v43
    v_cvt_pk_bf16_f32 v92, v40, v41
    v_cvt_pk_bf16_f32 v93, v42, v43
    v_mfma_f32_32x32x16_bf16 v[48:63], v[168:171], v[84:87], v[48:63]
    v_exp_f32 v44, v44
    v_exp_f32 v45, v45
    v_exp_f32 v46, v46
    v_exp_f32 v47, v47
    v_cvt_pk_bf16_f32 v94, v44, v45
    v_cvt_pk_bf16_f32 v95, v46, v47
    s_waitcnt vmcnt(3)
    ds_add_u32 v212, v214 offset:0
    v_mfma_f32_32x32x16_bf16 v[32:47], v[140:143], v[132:135], v[112:127]
    ds_read_b128 v[144:147], v172 offset:12160
    v_exp_f32 v16, v16
    v_exp_f32 v17, v17
    v_exp_f32 v18, v18
    v_exp_f32 v19, v19
    v_cvt_pk_bf16_f32 v80, v16, v17
    v_cvt_pk_bf16_f32 v81, v18, v19
    v_mfma_f32_32x32x8_bf16 v[32:47], v[148:149], v[138:139], v[32:47]
    ds_read_b128 v[156:159], v174 offset:11136
    v_exp_f32 v20, v20
    v_exp_f32 v21, v21
    v_exp_f32 v22, v22
    v_exp_f32 v23, v23
    v_cvt_pk_bf16_f32 v82, v20, v21
    v_cvt_pk_bf16_f32 v83, v22, v23
    v_mfma_f32_32x32x16_bf16 v[64:79], v[164:167], v[88:91], v[64:79]
    ds_read_b128 v[160:163], v174 offset:11840
    v_exp_f32 v24, v24
    v_exp_f32 v25, v25
    v_exp_f32 v26, v26
    v_exp_f32 v27, v27
    v_cvt_pk_bf16_f32 v84, v24, v25
    v_cvt_pk_bf16_f32 v85, v26, v27
    v_mfma_f32_32x32x16_bf16 v[64:79], v[168:171], v[92:95], v[64:79]
    v_exp_f32 v28, v28
    v_exp_f32 v29, v29
    v_exp_f32 v30, v30
    v_exp_f32 v31, v31
    v_cvt_pk_bf16_f32 v86, v28, v29
    v_cvt_pk_bf16_f32 v87, v30, v31
    s_waitcnt lgkmcnt(2)
    v_mfma_f32_32x32x16_bf16 v[16:31], v[144:147], v[128:131], v[96:111]
    v_exp_f32 v32, v32
    v_exp_f32 v33, v33
    v_exp_f32 v34, v34
    v_exp_f32 v35, v35
    v_cvt_pk_bf16_f32 v88, v32, v33
    v_cvt_pk_bf16_f32 v89, v34, v35
    v_mfma_f32_32x32x8_bf16 v[16:31], v[150:151], v[136:137], v[16:31]
    v_exp_f32 v36, v36
    v_exp_f32 v37, v37
    v_exp_f32 v38, v38
    v_exp_f32 v39, v39
    v_cvt_pk_bf16_f32 v90, v36, v37
    v_cvt_pk_bf16_f32 v91, v38, v39
    s_waitcnt lgkmcnt(0)
    v_mfma_f32_32x32x16_bf16 v[48:63], v[156:159], v[80:83], v[48:63]
    v_exp_f32 v40, v40
    v_exp_f32 v41, v41
    v_exp_f32 v42, v42
    v_exp_f32 v43, v43
    v_cvt_pk_bf16_f32 v92, v40, v41
    v_cvt_pk_bf16_f32 v93, v42, v43
    v_mfma_f32_32x32x16_bf16 v[48:63], v[160:163], v[84:87], v[48:63]
    ds_read_b32 v180, v213 offset:0
    v_exp_f32 v44, v44
    v_exp_f32 v45, v45
    v_exp_f32 v46, v46
    v_exp_f32 v47, v47
    v_cvt_pk_bf16_f32 v94, v44, v45
    v_cvt_pk_bf16_f32 v95, v46, v47
    v_mfma_f32_32x32x16_bf16 v[32:47], v[144:147], v[132:135], v[112:127]
    ds_read_b128 v[140:143], v172 offset:13184
    v_exp_f32 v16, v16
    v_exp_f32 v17, v17
    v_exp_f32 v18, v18
    v_exp_f32 v19, v19
    v_cvt_pk_bf16_f32 v80, v16, v17
    v_cvt_pk_bf16_f32 v81, v18, v19
    v_mfma_f32_32x32x8_bf16 v[32:47], v[150:151], v[138:139], v[32:47]
    ds_read_b128 v[152:155], v173 offset:11648
    v_exp_f32 v20, v20
    v_exp_f32 v21, v21
    v_exp_f32 v22, v22
    v_exp_f32 v23, v23
    v_cvt_pk_bf16_f32 v82, v20, v21
    v_cvt_pk_bf16_f32 v83, v22, v23
    v_mfma_f32_32x32x16_bf16 v[64:79], v[156:159], v[88:91], v[64:79]
    ds_read_b128 v[164:167], v174 offset:12544
    v_exp_f32 v24, v24
    v_exp_f32 v25, v25
    v_exp_f32 v26, v26
    v_exp_f32 v27, v27
    v_cvt_pk_bf16_f32 v84, v24, v25
    v_cvt_pk_bf16_f32 v85, v26, v27
    v_mfma_f32_32x32x16_bf16 v[64:79], v[160:163], v[92:95], v[64:79]
    ds_read_b128 v[168:171], v174 offset:13248
    v_exp_f32 v28, v28
    v_exp_f32 v29, v29
    v_exp_f32 v30, v30
    v_exp_f32 v31, v31
    v_cvt_pk_bf16_f32 v86, v28, v29
    v_cvt_pk_bf16_f32 v87, v30, v31
    s_waitcnt lgkmcnt(2)
    v_mfma_f32_32x32x16_bf16 v[16:31], v[140:143], v[128:131], v[96:111]
    v_cmp_gt_u32 vcc, s78, v180
    s_cbranch_vccz L_arr_28
    s_mov_b32 s62, 0
L_spin_29:
    ds_read_b32 v180, v213 offset:0
    s_waitcnt lgkmcnt(0)
    v_cmp_gt_u32 vcc, s78, v180
    s_cbranch_vccz L_spind_30
    s_add_u32 s62, s62, 1
    s_cmp_lt_u32 s62, 400000
    s_cbranch_scc1 L_spin_29
L_spind_30:
L_arr_28:
    v_exp_f32 v32, v32
    v_exp_f32 v33, v33
    v_exp_f32 v34, v34
    v_exp_f32 v35, v35
    v_cvt_pk_bf16_f32 v88, v32, v33
    v_cvt_pk_bf16_f32 v89, v34, v35
    v_mfma_f32_32x32x8_bf16 v[16:31], v[152:153], v[136:137], v[16:31]
    s_cmp_eq_u32 s74, 3
    s_cbranch_scc1 L_nd_31
    s_add_u32 m0, s72, 0
    s_add_u32 s73, s79, 12288
    buffer_load_dwordx4 v181, s[36:39], s79 offen offset:0 sc1 lds
    buffer_load_dwordx4 v181, s[36:39], s79 offen offset:1024 sc1 lds
    buffer_load_dwordx4 v181, s[36:39], s79 offen offset:2048 sc1 lds
    s_cmp_eq_u32 s73, 262144
    s_cselect_b32 s79, 65536, s73
L_nd_31:
    s_add_u32 s78, s78, 4
    v_exp_f32 v36, v36
    v_exp_f32 v37, v37
    v_exp_f32 v38, v38
    v_exp_f32 v39, v39
    v_cvt_pk_bf16_f32 v90, v36, v37
    v_cvt_pk_bf16_f32 v91, v38, v39
    s_waitcnt lgkmcnt(0)
    v_mfma_f32_32x32x16_bf16 v[48:63], v[164:167], v[80:83], v[48:63]
    v_exp_f32 v40, v40
    v_exp_f32 v41, v41
    v_exp_f32 v42, v42
    v_exp_f32 v43, v43
    v_cvt_pk_bf16_f32 v92, v40, v41
    v_cvt_pk_bf16_f32 v93, v42, v43
    v_mfma_f32_32x32x16_bf16 v[48:63], v[168:171], v[84:87], v[48:63]
    v_exp_f32 v44, v44
    v_exp_f32 v45, v45
    v_exp_f32 v46, v46
    v_exp_f32 v47, v47
    v_cvt_pk_bf16_f32 v94, v44, v45
    v_cvt_pk_bf16_f32 v95, v46, v47
    v_mfma_f32_32x32x16_bf16 v[32:47], v[140:143], v[132:135], v[112:127]
    ds_read_b128 v[144:147], v172 offset:14208
    v_exp_f32 v16, v16
    v_exp_f32 v17, v17
    v_exp_f32 v18, v18
    v_exp_f32 v19, v19
    v_cvt_pk_bf16_f32 v80, v16, v17
    v_cvt_pk_bf16_f32 v81, v18, v19
    v_mfma_f32_32x32x8_bf16 v[32:47], v[152:153], v[138:139], v[32:47]
    ds_read_b128 v[156:159], v174 offset:13952
    v_exp_f32 v20, v20
    v_exp_f32 v21, v21
    v_exp_f32 v22, v22
    v_exp_f32 v23, v23
    v_cvt_pk_bf16_f32 v82, v20, v21
    v_cvt_pk_bf16_f32 v83, v22, v23
    v_mfma_f32_32x32x16_bf16 v[64:79], v[164:167], v[88:91], v[64:79]
    ds_read_b128 v[160:163], v174 offset:14656
    v_exp_f32 v24, v24
    v_exp_f32 v25, v25
    v_exp_f32 v26, v26
    v_exp_f32 v27, v27
    v_cvt_pk_bf16_f32 v84, v24, v25
    v_cvt_pk_bf16_f32 v85, v26, v27
    v_mfma_f32_32x32x16_bf16 v[64:79], v[168:171], v[92:95], v[64:79]
    v_exp_f32 v28, v28
    v_exp_f32 v29, v29
    v_exp_f32 v30, v30
    v_exp_f32 v31, v31
    v_cvt_pk_bf16_f32 v86, v28, v29
    v_cvt_pk_bf16_f32 v87, v30, v31
    s_waitcnt lgkmcnt(2)
    v_mfma_f32_32x32x16_bf16 v[16:31], v[144:147], v[128:131], v[96:111]
    v_exp_f32 v32, v32
    v_exp_f32 v33, v33
    v_exp_f32 v34, v34
    v_exp_f32 v35, v35
    v_cvt_pk_bf16_f32 v88, v32, v33
    v_cvt_pk_bf16_f32 v89, v34, v35
    v_mfma_f32_32x32x8_bf16 v[16:31], v[154:155], v[136:137], v[16:31]
    v_exp_f32 v36, v36
    v_exp_f32 v37, v37
    v_exp_f32 v38, v38
    v_exp_f32 v39, v39
    v_cvt_pk_bf16_f32 v90, v36, v37
    v_cvt_pk_bf16_f32 v91, v38, v39
    s_waitcnt lgkmcnt(0)
    v_mfma_f32_32x32x16_bf16 v[48:63], v[156:159], v[80:83], v[48:63]
    v_exp_f32 v40, v40
    v_exp_f32 v41, v41
    v_exp_f32 v42, v42
    v_exp_f32 v43, v43
    v_cvt_pk_bf16_f32 v92, v40, v41
    v_cvt_pk_bf16_f32 v93, v42, v43
    v_mfma_f32_32x32x16_bf16 v[48:63], v[160:163], v[84:87], v[48:63]
    v_exp_f32 v44, v44
    v_exp_f32 v45, v45
    v_exp_f32 v46, v46
    v_exp_f32 v47, v47
    v_cvt_pk_bf16_f32 v94, v44, v45
    v_cvt_pk_bf16_f32 v95, v46, v47
    v_mfma_f32_32x32x16_bf16 v[32:47], v[144:147], v[132:135], v[112:127]
    ds_read_b128 v[140:143], v172 offset:22272
    v_exp_f32 v16, v16
    v_exp_f32 v17, v17
    v_exp_f32 v18, v18
    v_exp_f32 v19, v19
    v_cvt_pk_bf16_f32 v80, v16, v17
    v_cvt_pk_bf16_f32 v81, v18, v19
    v_mfma_f32_32x32x8_bf16 v[32:47], v[154:155], v[138:139], v[32:47]
    ds_read_b128 v[148:151], v173 offset:22272
    v_exp_f32 v20, v20
    v_exp_f32 v21, v21
    v_exp_f32 v22, v22
    v_exp_f32 v23, v23
    v_cvt_pk_bf16_f32 v82, v20, v21
    v_cvt_pk_bf16_f32 v83, v22, v23
    v_mfma_f32_32x32x16_bf16 v[64:79], v[156:159], v[88:91], v[64:79]
    ds_read_b128 v[164:167], v174 offset:15360
    v_exp_f32 v24, v24
    v_exp_f32 v25, v25
    v_exp_f32 v26, v26
    v_exp_f32 v27, v27
    v_cvt_pk_bf16_f32 v84, v24, v25
    v_cvt_pk_bf16_f32 v85, v26, v27
    v_mfma_f32_32x32x16_bf16 v[64:79], v[160:163], v[92:95], v[64:79]
    ds_read_b128 v[168:171], v174 offset:16064
    v_exp_f32 v28, v28
    v_exp_f32 v29, v29
    v_exp_f32 v30, v30
    v_exp_f32 v31, v31
    v_cvt_pk_bf16_f32 v86, v28, v29
    v_cvt_pk_bf16_f32 v87, v30, v31
    s_waitcnt lgkmcnt(2)
    v_mfma_f32_32x32x16_bf16 v[16:31], v[140:143], v[128:131], v[96:111]
    v_exp_f32 v32, v32
    v_exp_f32 v33, v33
    v_exp_f32 v34, v34
    v_exp_f32 v35, v35
    v_cvt_pk_bf16_f32 v88, v32, v33
    v_cvt_pk_bf16_f32 v89, v34, v35
    v_mfma_f32_32x32x8_bf16 v[16:31], v[148:149], v[136:137], v[16:31]
    v_exp_f32 v36, v36
    v_exp_f32 v37, v37
    v_exp_f32 v38, v38
    v_exp_f32 v39, v39
    v_cvt_pk_bf16_f32 v90, v36, v37
    v_cvt_pk_bf16_f32 v91, v38, v39
    s_waitcnt lgkmcnt(0)
    v_mfma_f32_32x32x16_bf16 v[48:63], v[164:167], v[80:83], v[48:63]
    v_exp_f32 v40, v40
    v_exp_f32 v41, v41
    v_exp_f32 v42, v42
    v_exp_f32 v43, v43
    v_cvt_pk_bf16_f32 v92, v40, v41
    v_cvt_pk_bf16_f32 v93, v42, v43
    v_mfma_f32_32x32x16_bf16 v[48:63], v[168:171], v[84:87], v[48:63]
    v_exp_f32 v44, v44
    v_exp_f32 v45, v45
    v_exp_f32 v46, v46
    v_exp_f32 v47, v47
    v_cvt_pk_bf16_f32 v94, v44, v45
    v_cvt_pk_bf16_f32 v95, v46, v47
    s_cmp_lg_u32 s74, 3
    s_cbranch_scc1 L_w3_32
    s_waitcnt vmcnt(0)
L_w3_32:
    s_waitcnt vmcnt(3)
    ds_add_u32 v212, v214 offset:0
    v_mfma_f32_32x32x16_bf16 v[32:47], v[140:143], v[132:135], v[112:127]
    ds_read_b128 v[144:147], v172 offset:23296
    v_exp_f32 v16, v16
    v_exp_f32 v17, v17
    v_exp_f32 v18, v18
    v_exp_f32 v19, v19
    v_cvt_pk_bf16_f32 v80, v16, v17
    v_cvt_pk_bf16_f32 v81, v18, v19
    v_mfma_f32_32x32x8_bf16 v[32:47], v[148:149], v[138:139], v[32:47]
    ds_read_b128 v[156:159], v174 offset:22272
    v_exp_f32 v20, v20
    v_exp_f32 v21, v21
    v_exp_f32 v22, v22
    v_exp_f32 v23, v23
    v_cvt_pk_bf16_f32 v82, v20, v21
    v_cvt_pk_bf16_f32 v83, v22, v23
    v_mfma_f32_32x32x16_bf16 v[64:79], v[164:167], v[88:91], v[64:79]
    ds_read_b128 v[160:163], v174 offset:22976
    v_exp_f32 v24, v24
    v_exp_f32 v25, v25
    v_exp_f32 v26, v26
    v_exp_f32 v27, v27
    v_cvt_pk_bf16_f32 v84, v24, v25
    v_cvt_pk_bf16_f32 v85, v26, v27
    v_mfma_f32_32x32x16_bf16 v[64:79], v[168:171], v[92:95], v[64:79]
    v_exp_f32 v28, v28
    v_exp_f32 v29, v29
    v_exp_f32 v30, v30
    v_exp_f32 v31, v31
    v_cvt_pk_bf16_f32 v86, v28, v29
    v_cvt_pk_bf16_f32 v87, v30, v31
    s_waitcnt lgkmcnt(2)
    v_mfma_f32_32x32x16_bf16 v[16:31], v[144:147], v[128:131], v[96:111]
    v_exp_f32 v32, v32
    v_exp_f32 v33, v33
    v_exp_f32 v34, v34
    v_exp_f32 v35, v35
    v_cvt_pk_bf16_f32 v88, v32, v33
    v_cvt_pk_bf16_f32 v89, v34, v35
    v_mfma_f32_32x32x8_bf16 v[16:31], v[150:151], v[136:137], v[16:31]
    v_exp_f32 v36, v36
    v_exp_f32 v37, v37
    v_exp_f32 v38, v38
    v_exp_f32 v39, v39
    v_cvt_pk_bf16_f32 v90, v36, v37
    v_cvt_pk_bf16_f32 v91, v38, v39
    s_waitcnt lgkmcnt(0)
    v_mfma_f32_32x32x16_bf16 v[48:63], v[156:159], v[80:83], v[48:63]
    v_exp_f32 v40, v40
    v_exp_f32 v41, v41
    v_exp_f32 v42, v42
    v_exp_f32 v43, v43
    v_cvt_pk_bf16_f32 v92, v40, v41
    v_cvt_pk_bf16_f32 v93, v42, v43
    v_mfma_f32_32x32x16_bf16 v[48:63], v[160:163], v[84:87], v[48:63]
    ds_read_b32 v180, v213 offset:0
    v_exp_f32 v44, v44
    v_exp_f32 v45, v45
    v_exp_f32 v46, v46
    v_exp_f32 v47, v47
    v_cvt_pk_bf16_f32 v94, v44, v45
    v_cvt_pk_bf16_f32 v95, v46, v47
    v_mfma_f32_32x32x16_bf16 v[32:47], v[144:147], v[132:135], v[112:127]
    ds_read_b128 v[140:143], v172 offset:24320
    v_exp_f32 v16, v16
    v_exp_f32 v17, v17
    v_exp_f32 v18, v18
    v_exp_f32 v19, v19
    v_cvt_pk_bf16_f32 v80, v16, v17
    v_cvt_pk_bf16_f32 v81, v18, v19
    v_mfma_f32_32x32x8_bf16 v[32:47], v[150:151], v[138:139], v[32:47]
    ds_read_b128 v[152:155], v173 offset:22784
    v_exp_f32 v20, v20
    v_exp_f32 v21, v21
    v_exp_f32 v22, v22
    v_exp_f32 v23, v23
    v_cvt_pk_bf16_f32 v82, v20, v21
    v_cvt_pk_bf16_f32 v83, v22, v23
    v_mfma_f32_32x32x16_bf16 v[64:79], v[156:159], v[88:91], v[64:79]
    ds_read_b128 v[164:167], v174 offset:23680
    v_exp_f32 v24, v24
    v_exp_f32 v25, v25
    v_exp_f32 v26, v26
    v_exp_f32 v27, v27
    v_cvt_pk_bf16_f32 v84, v24, v25
    v_cvt_pk_bf16_f32 v85, v26, v27
    v_mfma_f32_32x32x16_bf16 v[64:79], v[160:163], v[92:95], v[64:79]
    ds_read_b128 v[168:171], v174 offset:24384
    v_exp_f32 v28, v28
    v_exp_f32 v29, v29
    v_exp_f32 v30, v30
    v_exp_f32 v31, v31
    v_cvt_pk_bf16_f32 v86, v28, v29
    v_cvt_pk_bf16_f32 v87, v30, v31
    s_waitcnt lgkmcnt(2)
    v_mfma_f32_32x32x16_bf16 v[16:31], v[140:143], v[128:131], v[96:111]
    v_cmp_gt_u32 vcc, s78, v180
    s_cbranch_vccz L_arr_33
    s_mov_b32 s62, 0
L_spin_34:
    ds_read_b32 v180, v213 offset:0
    s_waitcnt lgkmcnt(0)
    v_cmp_gt_u32 vcc, s78, v180
    s_cbranch_vccz L_spind_35
    s_add_u32 s62, s62, 1
    s_cmp_lt_u32 s62, 400000
    s_cbranch_scc1 L_spin_34
L_spind_35:
L_arr_33:
    v_exp_f32 v32, v32
    v_exp_f32 v33, v33
    v_exp_f32 v34, v34
    v_exp_f32 v35, v35
    v_cvt_pk_bf16_f32 v88, v32, v33
    v_cvt_pk_bf16_f32 v89, v34, v35
    v_mfma_f32_32x32x8_bf16 v[16:31], v[152:153], v[136:137], v[16:31]
    s_cmp_eq_u32 s74, 3
    s_cbranch_scc1 L_nd_36
    s_add_u32 m0, s72, 11136
    s_add_u32 s73, s79, 12288
    buffer_load_dwordx4 v181, s[36:39], s79 offen offset:0 sc1 lds
    buffer_load_dwordx4 v181, s[36:39], s79 offen offset:1024 sc1 lds
    buffer_load_dwordx4 v181, s[36:39], s79 offen offset:2048 sc1 lds
    s_cmp_eq_u32 s73, 262144
    s_cselect_b32 s79, 65536, s73
L_nd_36:
    s_add_u32 s78, s78, 4
    v_exp_f32 v36, v36
    v_exp_f32 v37, v37
    v_exp_f32 v38, v38
    v_exp_f32 v39, v39
    v_cvt_pk_bf16_f32 v90, v36, v37
    v_cvt_pk_bf16_f32 v91, v38, v39
    s_waitcnt lgkmcnt(0)
    v_mfma_f32_32x32x16_bf16 v[48:63], v[164:167], v[80:83], v[48:63]
    v_exp_f32 v40, v40
    v_exp_f32 v41, v41
    v_exp_f32 v42, v42
    v_exp_f32 v43, v43
    v_cvt_pk_bf16_f32 v92, v40, v41
    v_cvt_pk_bf16_f32 v93, v42, v43
    v_mfma_f32_32x32x16_bf16 v[48:63], v[168:171], v[84:87], v[48:63]
    v_exp_f32 v44, v44
    v_exp_f32 v45, v45
    v_exp_f32 v46, v46
    v_exp_f32 v47, v47
    v_cvt_pk_bf16_f32 v94, v44, v45
    v_cvt_pk_bf16_f32 v95, v46, v47
    v_mfma_f32_32x32x16_bf16 v[32:47], v[140:143], v[132:135], v[112:127]
    ds_read_b128 v[144:147], v172 offset:25344
    v_exp_f32 v16, v16
    v_exp_f32 v17, v17
    v_exp_f32 v18, v18
    v_exp_f32 v19, v19
    v_cvt_pk_bf16_f32 v80, v16, v17
    v_cvt_pk_bf16_f32 v81, v18, v19
    v_mfma_f32_32x32x8_bf16 v[32:47], v[152:153], v[138:139], v[32:47]
    ds_read_b128 v[156:159], v174 offset:25088
    v_exp_f32 v20, v20
    v_exp_f32 v21, v21
    v_exp_f32 v22, v22
    v_exp_f32 v23, v23
    v_cvt_pk_bf16_f32 v82, v20, v21
    v_cvt_pk_bf16_f32 v83, v22, v23
    v_mfma_f32_32x32x16_bf16 v[64:79], v[164:167], v[88:91], v[64:79]
    ds_read_b128 v[160:163], v174 offset:25792
    v_exp_f32 v24, v24
    v_exp_f32 v25, v25
    v_exp_f32 v26, v26
    v_exp_f32 v27, v27
    v_cvt_pk_bf16_f32 v84, v24, v25
    v_cvt_pk_bf16_f32 v85, v26, v27
    v_mfma_f32_32x32x16_bf16 v[64:79], v[168:171], v[92:95], v[64:79]
    v_exp_f32 v28, v28
    v_exp_f32 v29, v29
    v_exp_f32 v30, v30
    v_exp_f32 v31, v31
    v_cvt_pk_bf16_f32 v86, v28, v29
    v_cvt_pk_bf16_f32 v87, v30, v31
    s_waitcnt lgkmcnt(2)
    v_mfma_f32_32x32x16_bf16 v[16:31], v[144:147], v[128:131], v[96:111]
    v_exp_f32 v32, v32
    v_exp_f32 v33, v33
    v_exp_f32 v34, v34
    v_exp_f32 v35, v35
    v_cvt_pk_bf16_f32 v88, v32, v33
    v_cvt_pk_bf16_f32 v89, v34, v35
    v_mfma_f32_32x32x8_bf16 v[16:31], v[154:155], v[136:137], v[16:31]
    v_exp_f32 v36, v36
    v_exp_f32 v37, v37
    v_exp_f32 v38, v38
    v_exp_f32 v39, v39
    v_cvt_pk_bf16_f32 v90, v36, v37
    v_cvt_pk_bf16_f32 v91, v38, v39
    s_waitcnt lgkmcnt(0)
    v_mfma_f32_32x32x16_bf16 v[48:63], v[156:159], v[80:83], v[48:63]
    v_exp_f32 v40, v40
    v_exp_f32 v41, v41
    v_exp_f32 v42, v42
    v_exp_f32 v43, v43
    v_cvt_pk_bf16_f32 v92, v40, v41
    v_cvt_pk_bf16_f32 v93, v42, v43
    v_mfma_f32_32x32x16_bf16 v[48:63], v[160:163], v[84:87], v[48:63]
    v_exp_f32 v44, v44
    v_exp_f32 v45, v45
    v_exp_f32 v46, v46
    v_exp_f32 v47, v47
    v_cvt_pk_bf16_f32 v94, v44, v45
    v_cvt_pk_bf16_f32 v95, v46, v47
    v_mfma_f32_32x32x16_bf16 v[32:47], v[144:147], v[132:135], v[112:127]
    ds_read_b128 v[140:143], v172 offset:33408
    v_exp_f32 v16, v16
    v_exp_f32 v17, v17
    v_exp_f32 v18, v18
    v_exp_f32 v19, v19
    v_cvt_pk_bf16_f32 v80, v16, v17
    v_cvt_pk_bf16_f32 v81, v18, v19
    v_mfma_f32_32x32x8_bf16 v[32:47], v[154:155], v[138:139], v[32:47]
    ds_read_b128 v[148:151], v173 offset:33408
    v_exp_f32 v20, v20
    v_exp_f32 v21, v21
    v_exp_f32 v22, v22
    v_exp_f32 v23, v23
    v_cvt_pk_bf16_f32 v82, v20, v21
    v_cvt_pk_bf16_f32 v83, v22, v23
    v_mfma_f32_32x32x16_bf16 v[64:79], v[156:159], v[88:91], v[64:79]
    ds_read_b128 v[164:167], v174 offset:26496
    v_exp_f32 v24, v24
    v_exp_f32 v25, v25
    v_exp_f32 v26, v26
    v_exp_f32 v27, v27
    v_cvt_pk_bf16_f32 v84, v24, v25
    v_cvt_pk_bf16_f32 v85, v26, v27
    v_mfma_f32_32x32x16_bf16 v[64:79], v[160:163], v[92:95], v[64:79]
    ds_read_b128 v[168:171], v174 offset:27200
    v_exp_f32 v28, v28
    v_exp_f32 v29, v29
    v_exp_f32 v30, v30
    v_exp_f32 v31, v31
    v_cvt_pk_bf16_f32 v86, v28, v29
    v_cvt_pk_bf16_f32 v87, v30, v31
    s_waitcnt lgkmcnt(2)
    v_mfma_f32_32x32x16_bf16 v[16:31], v[140:143], v[128:131], v[96:111]
    v_exp_f32 v32, v32
    v_exp_f32 v33, v33
    v_exp_f32 v34, v34
    v_exp_f32 v35, v35
    v_cvt_pk_bf16_f32 v88, v32, v33
    v_cvt_pk_bf16_f32 v89, v34, v35
    v_mfma_f32_32x32x8_bf16 v[16:31], v[148:149], v[136:137], v[16:31]
    v_exp_f32 v36, v36
    v_exp_f32 v37, v37
    v_exp_f32 v38, v38
    v_exp_f32 v39, v39
    v_cvt_pk_bf16_f32 v90, v36, v37
    v_cvt_pk_bf16_f32 v91, v38, v39
    s_waitcnt lgkmcnt(0)
    v_mfma_f32_32x32x16_bf16 v[48:63], v[164:167], v[80:83], v[48:63]
    v_exp_f32 v40, v40
    v_exp_f32 v41, v41
    v_exp_f32 v42, v42
    v_exp_f32 v43, v43
    v_cvt_pk_bf16_f32 v92, v40, v41
    v_cvt_pk_bf16_f32 v93, v42, v43
    v_mfma_f32_32x32x16_bf16 v[48:63], v[168:171], v[84:87], v[48:63]
    v_exp_f32 v44, v44
    v_exp_f32 v45, v45
    v_exp_f32 v46, v46
    v_exp_f32 v47, v47
    v_cvt_pk_bf16_f32 v94, v44, v45
    v_cvt_pk_bf16_f32 v95, v46, v47
    s_waitcnt vmcnt(3)
    ds_add_u32 v212, v214 offset:0
    v_mfma_f32_32x32x16_bf16 v[32:47], v[140:143], v[132:135], v[112:127]
    ds_read_b128 v[144:147], v172 offset:34432
    v_exp_f32 v16, v16
    v_exp_f32 v17, v17
    v_exp_f32 v18, v18
    v_exp_f32 v19, v19
    v_cvt_pk_bf16_f32 v80, v16, v17
    v_cvt_pk_bf16_f32 v81, v18, v19
    v_mfma_f32_32x32x8_bf16 v[32:47], v[148:149], v[138:139], v[32:47]
    ds_read_b128 v[156:159], v174 offset:33408
    v_exp_f32 v20, v20
    v_exp_f32 v21, v21
    v_exp_f32 v22, v22
    v_exp_f32 v23, v23
    v_cvt_pk_bf16_f32 v82, v20, v21
    v_cvt_pk_bf16_f32 v83, v22, v23
    v_mfma_f32_32x32x16_bf16 v[64:79], v[164:167], v[88:91], v[64:79]
    ds_read_b128 v[160:163], v174 offset:34112
    v_exp_f32 v24, v24
    v_exp_f32 v25, v25
    v_exp_f32 v26, v26
    v_exp_f32 v27, v27
    v_cvt_pk_bf16_f32 v84, v24, v25
    v_cvt_pk_bf16_f32 v85, v26, v27
    v_mfma_f32_32x32x16_bf16 v[64:79], v[168:171], v[92:95], v[64:79]
    v_exp_f32 v28, v28
    v_exp_f32 v29, v29
    v_exp_f32 v30, v30
    v_exp_f32 v31, v31
    v_cvt_pk_bf16_f32 v86, v28, v29
    v_cvt_pk_bf16_f32 v87, v30, v31
    s_waitcnt lgkmcnt(2)
    v_mfma_f32_32x32x16_bf16 v[16:31], v[144:147], v[128:131], v[96:111]
    v_exp_f32 v32, v32
    v_exp_f32 v33, v33
    v_exp_f32 v34, v34
    v_exp_f32 v35, v35
    v_cvt_pk_bf16_f32 v88, v32, v33
    v_cvt_pk_bf16_f32 v89, v34, v35
    v_mfma_f32_32x32x8_bf16 v[16:31], v[150:151], v[136:137], v[16:31]
    v_exp_f32 v36, v36
    v_exp_f32 v37, v37
    v_exp_f32 v38, v38
    v_exp_f32 v39, v39
    v_cvt_pk_bf16_f32 v90, v36, v37
    v_cvt_pk_bf16_f32 v91, v38, v39
    s_waitcnt lgkmcnt(0)
    v_mfma_f32_32x32x16_bf16 v[48:63], v[156:159], v[80:83], v[48:63]
    v_exp_f32 v40, v40
    v_exp_f32 v41, v41
    v_exp_f32 v42, v42
    v_exp_f32 v43, v43
    v_cvt_pk_bf16_f32 v92, v40, v41
    v_cvt_pk_bf16_f32 v93, v42, v43
    v_mfma_f32_32x32x16_bf16 v[48:63], v[160:163], v[84:87], v[48:63]
    ds_read_b32 v180, v213 offset:0
    v_exp_f32 v44, v44
    v_exp_f32 v45, v45
    v_exp_f32 v46, v46
    v_exp_f32 v47, v47
    v_cvt_pk_bf16_f32 v94, v44, v45
    v_cvt_pk_bf16_f32 v95, v46, v47
    v_mfma_f32_32x32x16_bf16 v[32:47], v[144:147], v[132:135], v[112:127]
    ds_read_b128 v[140:143], v172 offset:35456
    v_exp_f32 v16, v16
    v_exp_f32 v17, v17
    v_exp_f32 v18, v18
    v_exp_f32 v19, v19
    v_cvt_pk_bf16_f32 v80, v16, v17
    v_cvt_pk_bf16_f32 v81, v18, v19
    v_mfma_f32_32x32x8_bf16 v[32:47], v[150:151], v[138:139], v[32:47]
    ds_read_b128 v[152:155], v173 offset:33920
    v_exp_f32 v20, v20
    v_exp_f32 v21, v21
    v_exp_f32 v22, v22
    v_exp_f32 v23, v23
    v_cvt_pk_bf16_f32 v82, v20, v21
    v_cvt_pk_bf16_f32 v83, v22, v23
    v_mfma_f32_32x32x16_bf16 v[64:79], v[156:159], v[88:91], v[64:79]
    ds_read_b128 v[164:167], v174 offset:34816
    v_exp_f32 v24, v24
    v_exp_f32 v25, v25
    v_exp_f32 v26, v26
    v_exp_f32 v27, v27
    v_cvt_pk_bf16_f32 v84, v24, v25
    v_cvt_pk_bf16_f32 v85, v26, v27
    v_mfma_f32_32x32x16_bf16 v[64:79], v[160:163], v[92:95], v[64:79]
    ds_read_b128 v[168:171], v174 offset:35520
    v_exp_f32 v28, v28
    v_exp_f32 v29, v29
    v_exp_f32 v30, v30
    v_exp_f32 v31, v31
    v_cvt_pk_bf16_f32 v86, v28, v29
    v_cvt_pk_bf16_f32 v87, v30, v31
    s_waitcnt lgkmcnt(2)
    v_mfma_f32_32x32x16_bf16 v[16:31], v[140:143], v[128:131], v[96:111]
    v_cmp_gt_u32 vcc, s78, v180
    s_cbranch_vccz L_arr_37
    s_mov_b32 s62, 0
L_spin_38:
    ds_read_b32 v180, v213 offset:0
    s_waitcnt lgkmcnt(0)
    v_cmp_gt_u32 vcc, s78, v180
    s_cbranch_vccz L_spind_39
    s_add_u32 s62, s62, 1
    s_cmp_lt_u32 s62, 400000
    s_cbranch_scc1 L_spin_38
L_spind_39:
L_arr_37:
    v_exp_f32 v32, v32
    v_exp_f32 v33, v33
    v_exp_f32 v34, v34
    v_exp_f32 v35, v35
    v_cvt_pk_bf16_f32 v88, v32, v33
    v_cvt_pk_bf16_f32 v89, v34, v35
    v_mfma_f32_32x32x8_bf16 v[16:31], v[152:153], v[136:137], v[16:31]
    s_cmp_eq_u32 s74, 3
    s_cbranch_scc1 L_nd_40
    s_add_u32 m0, s72, 22272
    s_add_u32 s73, s79, 12288
    buffer_load_dwordx4 v181, s[36:39], s79 offen offset:0 sc1 lds
    buffer_load_dwordx4 v181, s[36:39], s79 offen offset:1024 sc1 lds
    buffer_load_dwordx4 v181, s[36:39], s79 offen offset:2048 sc1 lds
    s_cmp_eq_u32 s73, 262144
    s_cselect_b32 s79, 65536, s73
L_nd_40:
    s_add_u32 s78, s78, 4
    v_exp_f32 v36, v36
    v_exp_f32 v37, v37
    v_exp_f32 v38, v38
    v_exp_f32 v39, v39
    v_cvt_pk_bf16_f32 v90, v36, v37
    v_cvt_pk_bf16_f32 v91, v38, v39
    s_waitcnt lgkmcnt(0)
    v_mfma_f32_32x32x16_bf16 v[48:63], v[164:167], v[80:83], v[48:63]
    v_exp_f32 v40, v40
    v_exp_f32 v41, v41
    v_exp_f32 v42, v42
    v_exp_f32 v43, v43
    v_cvt_pk_bf16_f32 v92, v40, v41
    v_cvt_pk_bf16_f32 v93, v42, v43
    v_mfma_f32_32x32x16_bf16 v[48:63], v[168:171], v[84:87], v[48:63]
    v_exp_f32 v44, v44
    v_exp_f32 v45, v45
    v_exp_f32 v46, v46
    v_exp_f32 v47, v47
    v_cvt_pk_bf16_f32 v94, v44, v45
    v_cvt_pk_bf16_f32 v95, v46, v47
    v_mfma_f32_32x32x16_bf16 v[32:47], v[140:143], v[132:135], v[112:127]
    ds_read_b128 v[144:147], v172 offset:36480
    v_exp_f32 v16, v16
    v_exp_f32 v17, v17
    v_exp_f32 v18, v18
    v_exp_f32 v19, v19
    v_cvt_pk_bf16_f32 v80, v16, v17
    v_cvt_pk_bf16_f32 v81, v18, v19
    v_mfma_f32_32x32x8_bf16 v[32:47], v[152:153], v[138:139], v[32:47]
    ds_read_b128 v[156:159], v174 offset:36224
    v_exp_f32 v20, v20
    v_exp_f32 v21, v21
    v_exp_f32 v22, v22
    v_exp_f32 v23, v23
    v_cvt_pk_bf16_f32 v82, v20, v21
    v_cvt_pk_bf16_f32 v83, v22, v23
    v_mfma_f32_32x32x16_bf16 v[64:79], v[164:167], v[88:91], v[64:79]
    ds_read_b128 v[160:163], v174 offset:36928
    v_exp_f32 v24, v24
    v_exp_f32 v25, v25
    v_exp_f32 v26, v26
    v_exp_f32 v27, v27
    v_cvt_pk_bf16_f32 v84, v24, v25
    v_cvt_pk_bf16_f32 v85, v26, v27
    v_mfma_f32_32x32x16_bf16 v[64:79], v[168:171], v[92:95], v[64:79]
    v_exp_f32 v28, v28
    v_exp_f32 v29, v29
    v_exp_f32 v30, v30
    v_exp_f32 v31, v31
    v_cvt_pk_bf16_f32 v86, v28, v29
    v_cvt_pk_bf16_f32 v87, v30, v31
    s_waitcnt lgkmcnt(2)
    v_mfma_f32_32x32x16_bf16 v[16:31], v[144:147], v[128:131], v[96:111]
    v_exp_f32 v32, v32
    v_exp_f32 v33, v33
    v_exp_f32 v34, v34
    v_exp_f32 v35, v35
    v_cvt_pk_bf16_f32 v88, v32, v33
    v_cvt_pk_bf16_f32 v89, v34, v35
    v_mfma_f32_32x32x8_bf16 v[16:31], v[154:155], v[136:137], v[16:31]
    v_exp_f32 v36, v36
    v_exp_f32 v37, v37
    v_exp_f32 v38, v38
    v_exp_f32 v39, v39
    v_cvt_pk_bf16_f32 v90, v36, v37
    v_cvt_pk_bf16_f32 v91, v38, v39
    s_waitcnt lgkmcnt(0)
    v_mfma_f32_32x32x16_bf16 v[48:63], v[156:159], v[80:83], v[48:63]
    v_exp_f32 v40, v40
    v_exp_f32 v41, v41
    v_exp_f32 v42, v42
    v_exp_f32 v43, v43
    v_cvt_pk_bf16_f32 v92, v40, v41
    v_cvt_pk_bf16_f32 v93, v42, v43
    v_mfma_f32_32x32x16_bf16 v[48:63], v[160:163], v[84:87], v[48:63]
    v_exp_f32 v44, v44
    v_exp_f32 v45, v45
    v_exp_f32 v46, v46
    v_exp_f32 v47, v47
    v_cvt_pk_bf16_f32 v94, v44, v45
    v_cvt_pk_bf16_f32 v95, v46, v47
    v_mfma_f32_32x32x16_bf16 v[32:47], v[144:147], v[132:135], v[112:127]
    ds_read_b128 v[140:143], v172 offset:0
    v_exp_f32 v16, v16
    v_exp_f32 v17, v17
    v_exp_f32 v18, v18
    v_exp_f32 v19, v19
    v_cvt_pk_bf16_f32 v80, v16, v17
    v_cvt_pk_bf16_f32 v81, v18, v19
    v_mfma_f32_32x32x8_bf16 v[32:47], v[154:155], v[138:139], v[32:47]
    ds_read_b128 v[148:151], v173 offset:0
    v_exp_f32 v20, v20
    v_exp_f32 v21, v21
    v_exp_f32 v22, v22
    v_exp_f32 v23, v23
    v_cvt_pk_bf16_f32 v82, v20, v21
    v_cvt_pk_bf16_f32 v83, v22, v23
    v_mfma_f32_32x32x16_bf16 v[64:79], v[156:159], v[88:91], v[64:79]
    ds_read_b128 v[164:167], v174 offset:37632
    v_exp_f32 v24, v24
    v_exp_f32 v25, v25
    v_exp_f32 v26, v26
    v_exp_f32 v27, v27
    v_cvt_pk_bf16_f32 v84, v24, v25
    v_cvt_pk_bf16_f32 v85, v26, v27
    v_mfma_f32_32x32x16_bf16 v[64:79], v[160:163], v[92:95], v[64:79]
    ds_read_b128 v[168:171], v174 offset:38336
    v_exp_f32 v28, v28
    v_exp_f32 v29, v29
    v_exp_f32 v30, v30
    v_exp_f32 v31, v31
    v_cvt_pk_bf16_f32 v86, v28, v29
    v_cvt_pk_bf16_f32 v87, v30, v31
    s_waitcnt lgkmcnt(2)
    v_mfma_f32_32x32x16_bf16 v[16:31], v[140:143], v[128:131], v[96:111]
    v_exp_f32 v32, v32
    v_exp_f32 v33, v33
    v_exp_f32 v34, v34
    v_exp_f32 v35, v35
    v_cvt_pk_bf16_f32 v88, v32, v33
    v_cvt_pk_bf16_f32 v89, v34, v35
    v_mfma_f32_32x32x8_bf16 v[16:31], v[148:149], v[136:137], v[16:31]
    v_exp_f32 v36, v36
    v_exp_f32 v37, v37
    v_exp_f32 v38, v38
    v_exp_f32 v39, v39
    v_cvt_pk_bf16_f32 v90, v36, v37
    v_cvt_pk_bf16_f32 v91, v38, v39
    s_waitcnt lgkmcnt(0)
    v_mfma_f32_32x32x16_bf16 v[48:63], v[164:167], v[80:83], v[48:63]
    v_exp_f32 v40, v40
    v_exp_f32 v41, v41
    v_exp_f32 v42, v42
    v_exp_f32 v43, v43
    v_cvt_pk_bf16_f32 v92, v40, v41
    v_cvt_pk_bf16_f32 v93, v42, v43
    v_mfma_f32_32x32x16_bf16 v[48:63], v[168:171], v[84:87], v[48:63]
    v_exp_f32 v44, v44
    v_exp_f32 v45, v45
    v_exp_f32 v46, v46
    v_exp_f32 v47, v47
    v_cvt_pk_bf16_f32 v94, v44, v45
    v_cvt_pk_bf16_f32 v95, v46, v47
    s_add_u32 s74, s74, 1
    s_cmp_lt_u32 s74, 4
    s_cbranch_scc1 L_ATT
    v_mfma_f32_32x32x16_bf16 v[64:79], v[164:167], v[88:91], v[64:79]
    v_mfma_f32_32x32x16_bf16 v[64:79], v[168:171], v[92:95], v[64:79]
    v_cmp_gt_u32 vcc, 32, v0
    s_nop 1
    v_cndmask_b32 v216, v56, v60, vcc
    v_rcp_f32 v216, v216
    s_nop 0
    v_mov_b32 v217, v216
    v_pk_mul_f32 v[48:49], v[48:49], v[216:217]
    v_pk_mul_f32 v[50:51], v[50:51], v[216:217]
    v_pk_mul_f32 v[52:53], v[52:53], v[216:217]
    v_pk_mul_f32 v[54:55], v[54:55], v[216:217]
    v_pk_mul_f32 v[56:57], v[56:57], v[216:217]
    v_pk_mul_f32 v[58:59], v[58:59], v[216:217]
    v_cvt_pk_bf16_f32 v80, v48, v49
    v_cvt_pk_bf16_f32 v81, v50, v51
    v_cvt_pk_bf16_f32 v82, v52, v53
    v_cvt_pk_bf16_f32 v83, v54, v55
    v_cvt_pk_bf16_f32 v84, v56, v57
    v_cvt_pk_bf16_f32 v85, v58, v59
    s_add_u32 s68, s80, 0
    s_add_u32 s69, s68, s81
    buffer_store_dwordx4 v[80:83], v215, s[36:39], s69 offen sc1
    s_add_u32 s69, s68, s82
    s_mov_b32 exec_lo, -1
    s_mov_b32 exec_hi, 0
    buffer_store_dwordx2 v[84:85], v215, s[36:39], s69 offen sc1
    s_mov_b64 exec, -1
    v_cndmask_b32 v216, v72, v76, vcc
    v_rcp_f32 v216, v216
    s_nop 0
    v_mov_b32 v217, v216
    v_pk_mul_f32 v[64:65], v[64:65], v[216:217]
    v_pk_mul_f32 v[66:67], v[66:67], v[216:217]
    v_pk_mul_f32 v[68:69], v[68:69], v[216:217]
    v_pk_mul_f32 v[70:71], v[70:71], v[216:217]
    v_pk_mul_f32 v[72:73], v[72:73], v[216:217]
    v_pk_mul_f32 v[74:75], v[74:75], v[216:217]
    v_cvt_pk_bf16_f32 v88, v64, v65
    v_cvt_pk_bf16_f32 v89, v66, v67
    v_cvt_pk_bf16_f32 v90, v68, v69
    v_cvt_pk_bf16_f32 v91, v70, v71
    v_cvt_pk_bf16_f32 v92, v72, v73
    v_cvt_pk_bf16_f32 v93, v74, v75
    s_add_u32 s68, s80, 40960
    s_add_u32 s69, s68, s81
    buffer_store_dwordx4 v[88:91], v215, s[36:39], s69 offen sc1
    s_add_u32 s69, s68, s82
    s_mov_b32 exec_lo, -1
    s_mov_b32 exec_hi, 0
    buffer_store_dwordx2 v[92:93], v215, s[36:39], s69 offen sc1
    s_mov_b64 exec, -1
    s_waitcnt vmcnt(0)
    ds_add_rtn_u32 v218, v212, v214 offset:32
    s_waitcnt lgkmcnt(0)
    v_readfirstlane_b32 s62, v218
    s_nop 0
    s_cmp_lg_u32 s62, 3
    s_cbranch_scc1 L_AEND
    s_lshl_b32 s62, s4, 7
    s_lshl_b32 s63, s5, 2
    s_add_u32 s62, s62, s63
    s_add_u32 s62, s62, 24576
    v_mov_b32 v217, s6
    v_mov_b32 v216, 0
    s_mov_b64 exec, 1
    buffer_store_dword v217, v216, s[36:39], s62 offen sc1
    s_mov_b64 exec, -1
L_AEND:
    s_branch L_END
L_ROLE_B:
    s_and_b32 s62, s5, 3
    s_cmp_lg_u32 s62, 0
    s_cbranch_scc1 L_ffn1_41
    s_cmp_ge_u32 s7, 2
    s_cbranch_scc1 L_kvidle_44
    s_setprio 3
    s_cmp_eq_u32 s5, 4
    s_cbranch_scc1 L_vjob_42
    ds_read_b64_tr_b16 v[48:49], v252 offset:0
    ds_read_b64_tr_b16 v[50:51], v252 offset:160
    ds_read_b128 v[52:55], v112 offset:0
    ds_read_b64_tr_b16 v[56:57], v252 offset:640
    ds_read_b64_tr_b16 v[58:59], v252 offset:800
    ds_read_b128 v[60:63], v113 offset:1024
    ds_read_b64_tr_b16 v[64:65], v252 offset:1280
    ds_read_b64_tr_b16 v[66:67], v252 offset:1440
    ds_read_b128 v[68:71], v114 offset:2048
    s_waitcnt lgkmcnt(6)
    v_mfma_f32_32x32x16_bf16 v[16:31], v[48:51], v[52:55], 0
    ds_read_b64_tr_b16 v[72:73], v252 offset:1920
    ds_read_b64_tr_b16 v[74:75], v252 offset:2080
    ds_read_b128 v[76:79], v115 offset:3072
    s_waitcnt lgkmcnt(6)
    v_mfma_f32_32x32x16_bf16 v[16:31], v[56:59], v[60:63], v[16:31]
    ds_read_b64_tr_b16 v[48:49], v252 offset:2560
    ds_read_b64_tr_b16 v[50:51], v252 offset:2720
    ds_read_b128 v[52:55], v112 offset:4096
    s_waitcnt lgkmcnt(6)
    v_mfma_f32_32x32x16_bf16 v[16:31], v[64:67], v[68:71], v[16:31]
    ds_read_b64_tr_b16 v[56:57], v252 offset:3200
    ds_read_b64_tr_b16 v[58:59], v252 offset:3360
    ds_read_b128 v[60:63], v113 offset:5120
    s_waitcnt lgkmcnt(6)
    v_mfma_f32_32x32x16_bf16 v[16:31], v[72:75], v[76:79], v[16:31]
    ds_read_b64_tr_b16 v[64:65], v252 offset:3840
    ds_read_b64_tr_b16 v[66:67], v252 offset:4000
    ds_read_b128 v[68:71], v114 offset:6144
    s_waitcnt lgkmcnt(6)
    v_mfma_f32_32x32x16_bf16 v[16:31], v[48:51], v[52:55], v[16:31]
    ds_read_b64_tr_b16 v[72:73], v252 offset:4480
    ds_read_b64_tr_b16 v[74:75], v252 offset:4640
    ds_read_b128 v[76:79], v115 offset:7168
    s_waitcnt lgkmcnt(6)
    v_mfma_f32_32x32x16_bf16 v[16:31], v[56:59], v[60:63], v[16:31]
    ds_read_b64_tr_b16 v[48:49], v252 offset:5120
    ds_read_b64_tr_b16 v[50:51], v252 offset:5280
    ds_read_b128 v[52:55], v112 offset:8192
    s_waitcnt lgkmcnt(6)
    v_mfma_f32_32x32x16_bf16 v[16:31], v[64:67], v[68:71], v[16:31]
    ds_read_b64_tr_b16 v[56:57], v252 offset:5760
    ds_read_b64_tr_b16 v[58:59], v252 offset:5920
    ds_read_b128 v[60:63], v113 offset:9216
    s_waitcnt lgkmcnt(6)
    v_mfma_f32_32x32x16_bf16 v[16:31], v[72:75], v[76:79], v[16:31]
    ds_read_b64_tr_b16 v[64:65], v252 offset:6400
    ds_read_b64_tr_b16 v[66:67], v252 offset:6560
    ds_read_b128 v[68:71], v114 offset:10240
    s_waitcnt lgkmcnt(6)
    v_mfma_f32_32x32x16_bf16 v[16:31], v[48:51], v[52:55], v[16:31]
    ds_read_b64_tr_b16 v[72:73], v252 offset:7040
    ds_read_b64_tr_b16 v[74:75], v252 offset:7200
    ds_read_b128 v[76:79], v115 offset:11264
    s_waitcnt lgkmcnt(6)
    v_mfma_f32_32x32x16_bf16 v[16:31], v[56:59], v[60:63], v[16:31]
    ds_read_b64_tr_b16 v[48:49], v252 offset:7680
    ds_read_b64_tr_b16 v[50:51], v252 offset:7840
    ds_read_b128 v[52:55], v112 offset:12288
    s_waitcnt lgkmcnt(6)
    v_mfma_f32_32x32x16_bf16 v[16:31], v[64:67], v[68:71], v[16:31]
    ds_read_b64_tr_b16 v[56:57], v252 offset:8320
    ds_read_b64_tr_b16 v[58:59], v252 offset:8480
    ds_read_b128 v[60:63], v113 offset:13312
    s_waitcnt lgkmcnt(6)
    v_mfma_f32_32x32x16_bf16 v[16:31], v[72:75], v[76:79], v[16:31]
    ds_read_b64_tr_b16 v[64:65], v252 offset:8960
    ds_read_b64_tr_b16 v[66:67], v252 offset:9120
    ds_read_b128 v[68:71], v114 offset:14336
    s_waitcnt lgkmcnt(6)
    v_mfma_f32_32x32x16_bf16 v[16:31], v[48:51], v[52:55], v[16:31]
    ds_read_b64_tr_b16 v[72:73], v252 offset:9600
    ds_read_b64_tr_b16 v[74:75], v252 offset:9760
    ds_read_b128 v[76:79], v115 offset:15360
    s_waitcnt lgkmcnt(6)
    v_mfma_f32_32x32x16_bf16 v[16:31], v[56:59], v[60:63], v[16:31]
    ds_read_b64_tr_b16 v[48:49], v252 offset:10240
    ds_read_b64_tr_b16 v[50:51], v252 offset:10400
    ds_read_b128 v[52:55], v112 offset:16384
    s_waitcnt lgkmcnt(6)
    v_mfma_f32_32x32x16_bf16 v[16:31], v[64:67], v[68:71], v[16:31]
    ds_read_b64_tr_b16 v[56:57], v252 offset:10880
    ds_read_b64_tr_b16 v[58:59], v252 offset:11040
    ds_read_b128 v[60:63], v113 offset:17408
    s_waitcnt lgkmcnt(6)
    v_mfma_f32_32x32x16_bf16 v[16:31], v[72:75], v[76:79], v[16:31]
    ds_read_b64_tr_b16 v[64:65], v252 offset:11520
    ds_read_b64_tr_b16 v[66:67], v252 offset:11680
    ds_read_b128 v[68:71], v114 offset:18432
    s_waitcnt lgkmcnt(6)
    v_mfma_f32_32x32x16_bf16 v[16:31], v[48:51], v[52:55], v[16:31]
    ds_read_b64_tr_b16 v[72:73], v252 offset:12160
    ds_read_b64_tr_b16 v[74:75], v252 offset:12320
    ds_read_b128 v[76:79], v115 offset:19456
    s_waitcnt lgkmcnt(6)
    v_mfma_f32_32x32x16_bf16 v[16:31], v[56:59], v[60:63], v[16:31]
    ds_read_b64_tr_b16 v[48:49], v252 offset:12800
    ds_read_b64_tr_b16 v[50:51], v252 offset:12960
    ds_read_b128 v[52:55], v112 offset:20480
    s_waitcnt lgkmcnt(6)
    v_mfma_f32_32x32x16_bf16 v[16:31], v[64:67], v[68:71], v[16:31]
    ds_read_b64_tr_b16 v[56:57], v252 offset:13440
    ds_read_b64_tr_b16 v[58:59], v252 offset:13600
    ds_read_b128 v[60:63], v113 offset:21504
    s_waitcnt lgkmcnt(6)
    v_mfma_f32_32x32x16_bf16 v[16:31], v[72:75], v[76:79], v[16:31]
    ds_read_b64_tr_b16 v[64:65], v252 offset:14080
    ds_read_b64_tr_b16 v[66:67], v252 offset:14240
    ds_read_b128 v[68:71], v114 offset:22528
    s_waitcnt lgkmcnt(6)
    v_mfma_f32_32x32x16_bf16 v[16:31], v[48:51], v[52:55], v[16:31]
    ds_read_b64_tr_b16 v[72:73], v252 offset:14720
    ds_read_b64_tr_b16 v[74:75], v252 offset:14880
    ds_read_b128 v[76:79], v115 offset:23552
    s_waitcnt lgkmcnt(6)
    v_mfma_f32_32x32x16_bf16 v[16:31], v[56:59], v[60:63], v[16:31]
    ds_read_b64_tr_b16 v[48:49], v252 offset:15360
    ds_read_b64_tr_b16 v[50:51], v252 offset:15520
    ds_read_b128 v[52:55], v112 offset:24576
    s_waitcnt lgkmcnt(6)
    v_mfma_f32_32x32x16_bf16 v[16:31], v[64:67], v[68:71], v[16:31]
    ds_read_b64_tr_b16 v[56:57], v252 offset:16000
    ds_read_b64_tr_b16 v[58:59], v252 offset:16160
    ds_read_b128 v[60:63], v113 offset:25600
    s_waitcnt lgkmcnt(6)
    v_mfma_f32_32x32x16_bf16 v[16:31], v[72:75], v[76:79], v[16:31]
    ds_read_b64_tr_b16 v[64:65], v252 offset:16640
    ds_read_b64_tr_b16 v[66:67], v252 offset:16800
    ds_read_b128 v[68:71], v114 offset:26624
    s_waitcnt lgkmcnt(6)
    v_mfma_f32_32x32x16_bf16 v[16:31], v[48:51], v[52:55], v[16:31]
    ds_read_b64_tr_b16 v[72:73], v252 offset:17280
    ds_read_b64_tr_b16 v[74:75], v252 offset:17440
    ds_read_b128 v[76:79], v115 offset:27648
    s_waitcnt lgkmcnt(6)
    v_mfma_f32_32x32x16_bf16 v[16:31], v[56:59], v[60:63], v[16:31]
    ds_read_b64_tr_b16 v[48:49], v252 offset:17920
    ds_read_b64_tr_b16 v[50:51], v252 offset:18080
    ds_read_b128 v[52:55], v112 offset:28672
    s_waitcnt lgkmcnt(6)
    v_mfma_f32_32x32x16_bf16 v[16:31], v[64:67], v[68:71], v[16:31]
    ds_read_b64_tr_b16 v[56:57], v252 offset:18560
    ds_read_b64_tr_b16 v[58:59], v252 offset:18720
    ds_read_b128 v[60:63], v113 offset:29696
    s_waitcnt lgkmcnt(6)
    v_mfma_f32_32x32x16_bf16 v[16:31], v[72:75], v[76:79], v[16:31]
    ds_read_b64_tr_b16 v[64:65], v252 offset:19200
    ds_read_b64_tr_b16 v[66:67], v252 offset:19360
    ds_read_b128 v[68:71], v114 offset:30720
    s_waitcnt lgkmcnt(6)
    v_mfma_f32_32x32x16_bf16 v[16:31], v[48:51], v[52:55], v[16:31]
    ds_read_b64_tr_b16 v[72:73], v252 offset:19840
    ds_read_b64_tr_b16 v[74:75], v252 offset:20000
    ds_read_b128 v[76:79], v115 offset:31744
    s_waitcnt lgkmcnt(6)
    v_mfma_f32_32x32x16_bf16 v[16:31], v[56:59], v[60:63], v[16:31]
    ds_read_b64_tr_b16 v[48:49], v252 offset:20480
    ds_read_b64_tr_b16 v[50:51], v252 offset:20640
    ds_read_b128 v[52:55], v112 offset:32768
    s_waitcnt lgkmcnt(6)
    v_mfma_f32_32x32x16_bf16 v[16:31], v[64:67], v[68:71], v[16:31]
    ds_read_b64_tr_b16 v[56:57], v252 offset:21120
    ds_read_b64_tr_b16 v[58:59], v252 offset:21280
    ds_read_b128 v[60:63], v113 offset:33792
    s_waitcnt lgkmcnt(6)
    v_mfma_f32_32x32x16_bf16 v[16:31], v[72:75], v[76:79], v[16:31]
    ds_read_b64_tr_b16 v[64:65], v252 offset:21760
    ds_read_b64_tr_b16 v[66:67], v252 offset:21920
    ds_read_b128 v[68:71], v114 offset:34816
    s_waitcnt lgkmcnt(6)
    v_mfma_f32_32x32x16_bf16 v[16:31], v[48:51], v[52:55], v[16:31]
    ds_read_b64_tr_b16 v[72:73], v252 offset:22400
    ds_read_b64_tr_b16 v[74:75], v252 offset:22560
    ds_read_b128 v[76:79], v115 offset:35840
    s_waitcnt lgkmcnt(6)
    v_mfma_f32_32x32x16_bf16 v[16:31], v[56:59], v[60:63], v[16:31]
    ds_read_b64_tr_b16 v[48:49], v252 offset:23040
    ds_read_b64_tr_b16 v[50:51], v252 offset:23200
    ds_read_b128 v[52:55], v112 offset:36864
    s_waitcnt lgkmcnt(6)
    v_mfma_f32_32x32x16_bf16 v[16:31], v[64:67], v[68:71], v[16:31]
    ds_read_b64_tr_b16 v[56:57], v252 offset:23680
    ds_read_b64_tr_b16 v[58:59], v252 offset:23840
    ds_read_b128 v[60:63], v113 offset:37888
    s_waitcnt lgkmcnt(6)
    v_mfma_f32_32x32x16_bf16 v[16:31], v[72:75], v[76:79], v[16:31]
    ds_read_b64_tr_b16 v[64:65], v252 offset:24320
    ds_read_b64_tr_b16 v[66:67], v252 offset:24480
    ds_read_b128 v[68:71], v114 offset:38912
    s_waitcnt lgkmcnt(6)
    v_mfma_f32_32x32x16_bf16 v[16:31], v[48:51], v[52:55], v[16:31]
    ds_read_b64_tr_b16 v[72:73], v252 offset:24960
    ds_read_b64_tr_b16 v[74:75], v252 offset:25120
    ds_read_b128 v[76:79], v115 offset:39936
    s_waitcnt lgkmcnt(6)
    v_mfma_f32_32x32x16_bf16 v[16:31], v[56:59], v[60:63], v[16:31]
    s_waitcnt lgkmcnt(3)
    v_mfma_f32_32x32x16_bf16 v[16:31], v[64:67], v[68:71], v[16:31]
    s_waitcnt lgkmcnt(0)
    v_mfma_f32_32x32x16_bf16 v[16:31], v[72:75], v[76:79], v[16:31]
    s_lshr_b32 s62, s4, 1
    s_mul_i32 s62, s62, 12288
    s_add_u32 s62, s62, 65536
    s_and_b32 s63, s4, 1
    s_lshl_b32 s65, s63, 1
    s_add_u32 s65, s65, s7
    v_and_b32 v93, 31, v0
    v_lshrrev_b32 v95, 5, v0
    s_lshl_b32 s64, s65, 10
    s_add_u32 s64, s62, s64
    s_lshl_b32 s63, s63, 9
    s_add_u32 s62, s62, s63
    s_lshl_b32 s63, s7, 3
    s_add_u32 s62, s62, s63
    s_add_u32 s62, s62, 4096
    v_cmp_gt_u32 vcc, 32, v0
    s_nop 1
    v_cvt_pk_bf16_f32 v88, v16, v17
    v_cvt_pk_bf16_f32 v89, v18, v19
    v_cvt_pk_bf16_f32 v90, v20, v21
    v_cvt_pk_bf16_f32 v91, v22, v23
    v_cvt_pk_bf16_f32 v96, v24, v25
    v_cvt_pk_bf16_f32 v97, v26, v27
    buffer_store_dwordx4 v[88:91], v245, s[36:39], s64 offen sc1
    s_mov_b32 exec_lo, -1
    s_mov_b32 exec_hi, 0
    buffer_store_dwordx2 v[96:97], v245, s[36:39], s62 offen sc1
    s_mov_b64 exec, -1
    v_mul_f32 v92, v24, v24
    v_fmac_f32 v92, v25, v25
    v_fmac_f32 v92, v26, v26
    v_fmac_f32 v92, v27, v27
    s_nop 0
    v_cndmask_b32 v92, 0, v92, vcc
    v_fmac_f32 v92, v16, v16
    v_fmac_f32 v92, v17, v17
    v_fmac_f32 v92, v18, v18
    v_fmac_f32 v92, v19, v19
    v_fmac_f32 v92, v20, v20
    v_fmac_f32 v92, v21, v21
    v_fmac_f32 v92, v22, v22
    v_fmac_f32 v92, v23, v23
    v_mov_b32 v93, v92
    s_nop 1
    v_permlane32_swap_b32 v92, v93
    s_nop 0
    v_add_f32 v92, v92, v93
    s_nop 1
    v_max_f32_dpp v92, v92, v92 row_shr:1 row_mask:0xf bank_mask:0xf
    s_nop 1
    v_max_f32_dpp v92, v92, v92 row_shr:2 row_mask:0xf bank_mask:0xf
    s_nop 1
    v_max_f32_dpp v92, v92, v92 row_shr:4 row_mask:0xf bank_mask:0xf
    s_nop 1
    v_max_f32_dpp v92, v92, v92 row_shr:8 row_mask:0xf bank_mask:0xf
    s_nop 1
    v_max_f32_dpp v92, v92, v92 row_bcast:15 row_mask:0xa bank_mask:0xf
    s_nop 1
    v_max_f32_dpp v92, v92, v92 row_bcast:31 row_mask:0xc bank_mask:0xf
    s_nop 0
    v_readlane_b32 s63, v92, 63
    s_lshl_b32 s62, s4, 1
    s_add_u32 s62, s62, s7
    s_lshl_b32 s62, s62, 2
    s_add_u32 s62, s62, 32768
    v_mov_b32 v92, s63
    v_mov_b32 v93, 0
    s_mov_b64 exec, 1
    buffer_store_dword v92, v93, s[36:39], s62 offen sc1
    s_mov_b64 exec, -1
    s_waitcnt vmcnt(0)
    ds_add_rtn_u32 v248, v242, v244 offset:4
    s_waitcnt lgkmcnt(0)
    v_readfirstlane_b32 s62, v248
    s_nop 0
    s_cmp_lg_u32 s62, 1
    s_cbranch_scc1 L_kvnf_45
    v_lshlrev_b32 v92, 8, v0
    v_mov_b32 v93, s6
    s_lshl_b32 s62, s4, 1
    s_add_u32 s62, s62, 0
    s_lshl_b32 s62, s62, 2
    s_add_u32 s62, s62, 4096
    s_mov_b32 exec_lo, -1
    s_mov_b32 exec_hi, 0
    buffer_store_dword v93, v92, s[36:39], s62 offen sc1
    s_mov_b64 exec, -1
L_kvnf_45:
    s_branch L_kvidle_44
L_vjob_42:
    ds_read_b64_tr_b16 v[48:49], v252 offset:0
    ds_read_b64_tr_b16 v[50:51], v252 offset:160
    ds_read_b128 v[52:55], v112 offset:0
    ds_read_b64_tr_b16 v[56:57], v252 offset:640
    ds_read_b64_tr_b16 v[58:59], v252 offset:800
    ds_read_b128 v[60:63], v113 offset:1024
    ds_read_b64_tr_b16 v[64:65], v252 offset:1280
    ds_read_b64_tr_b16 v[66:67], v252 offset:1440
    ds_read_b128 v[68:71], v114 offset:2048
    s_waitcnt lgkmcnt(6)
    v_mfma_f32_32x32x16_bf16 v[16:31], v[52:55], v[48:51], 0
    ds_read_b64_tr_b16 v[72:73], v252 offset:1920
    ds_read_b64_tr_b16 v[74:75], v252 offset:2080
    ds_read_b128 v[76:79], v115 offset:3072
    s_waitcnt lgkmcnt(6)
    v_mfma_f32_32x32x16_bf16 v[16:31], v[60:63], v[56:59], v[16:31]
    ds_read_b64_tr_b16 v[48:49], v252 offset:2560
    ds_read_b64_tr_b16 v[50:51], v252 offset:2720
    ds_read_b128 v[52:55], v112 offset:4096
    s_waitcnt lgkmcnt(6)
    v_mfma_f32_32x32x16_bf16 v[16:31], v[68:71], v[64:67], v[16:31]
    ds_read_b64_tr_b16 v[56:57], v252 offset:3200
    ds_read_b64_tr_b16 v[58:59], v252 offset:3360
    ds_read_b128 v[60:63], v113 offset:5120
    s_waitcnt lgkmcnt(6)
    v_mfma_f32_32x32x16_bf16 v[16:31], v[76:79], v[72:75], v[16:31]
    ds_read_b64_tr_b16 v[64:65], v252 offset:3840
    ds_read_b64_tr_b16 v[66:67], v252 offset:4000
    ds_read_b128 v[68:71], v114 offset:6144
    s_waitcnt lgkmcnt(6)
    v_mfma_f32_32x32x16_bf16 v[16:31], v[52:55], v[48:51], v[16:31]
    ds_read_b64_tr_b16 v[72:73], v252 offset:4480
    ds_read_b64_tr_b16 v[74:75], v252 offset:4640
    ds_read_b128 v[76:79], v115 offset:7168
    s_waitcnt lgkmcnt(6)
    v_mfma_f32_32x32x16_bf16 v[16:31], v[60:63], v[56:59], v[16:31]
    ds_read_b64_tr_b16 v[48:49], v252 offset:5120
    ds_read_b64_tr_b16 v[50:51], v252 offset:5280
    ds_read_b128 v[52:55], v112 offset:8192
    s_waitcnt lgkmcnt(6)
    v_mfma_f32_32x32x16_bf16 v[16:31], v[68:71], v[64:67], v[16:31]
    ds_read_b64_tr_b16 v[56:57], v252 offset:5760
    ds_read_b64_tr_b16 v[58:59], v252 offset:5920
    ds_read_b128 v[60:63], v113 offset:9216
    s_waitcnt lgkmcnt(6)
    v_mfma_f32_32x32x16_bf16 v[16:31], v[76:79], v[72:75], v[16:31]
    ds_read_b64_tr_b16 v[64:65], v252 offset:6400
    ds_read_b64_tr_b16 v[66:67], v252 offset:6560
    ds_read_b128 v[68:71], v114 offset:10240
    s_waitcnt lgkmcnt(6)
    v_mfma_f32_32x32x16_bf16 v[16:31], v[52:55], v[48:51], v[16:31]
    ds_read_b64_tr_b16 v[72:73], v252 offset:7040
    ds_read_b64_tr_b16 v[74:75], v252 offset:7200
    ds_read_b128 v[76:79], v115 offset:11264
    s_waitcnt lgkmcnt(6)
    v_mfma_f32_32x32x16_bf16 v[16:31], v[60:63], v[56:59], v[16:31]
    ds_read_b64_tr_b16 v[48:49], v252 offset:7680
    ds_read_b64_tr_b16 v[50:51], v252 offset:7840
    ds_read_b128 v[52:55], v112 offset:12288
    s_waitcnt lgkmcnt(6)
    v_mfma_f32_32x32x16_bf16 v[16:31], v[68:71], v[64:67], v[16:31]
    ds_read_b64_tr_b16 v[56:57], v252 offset:8320
    ds_read_b64_tr_b16 v[58:59], v252 offset:8480
    ds_read_b128 v[60:63], v113 offset:13312
    s_waitcnt lgkmcnt(6)
    v_mfma_f32_32x32x16_bf16 v[16:31], v[76:79], v[72:75], v[16:31]
    ds_read_b64_tr_b16 v[64:65], v252 offset:8960
    ds_read_b64_tr_b16 v[66:67], v252 offset:9120
    ds_read_b128 v[68:71], v114 offset:14336
    s_waitcnt lgkmcnt(6)
    v_mfma_f32_32x32x16_bf16 v[16:31], v[52:55], v[48:51], v[16:31]
    ds_read_b64_tr_b16 v[72:73], v252 offset:9600
    ds_read_b64_tr_b16 v[74:75], v252 offset:9760
    ds_read_b128 v[76:79], v115 offset:15360
    s_waitcnt lgkmcnt(6)
    v_mfma_f32_32x32x16_bf16 v[16:31], v[60:63], v[56:59], v[16:31]
    ds_read_b64_tr_b16 v[48:49], v252 offset:10240
    ds_read_b64_tr_b16 v[50:51], v252 offset:10400
    ds_read_b128 v[52:55], v112 offset:16384
    s_waitcnt lgkmcnt(6)
    v_mfma_f32_32x32x16_bf16 v[16:31], v[68:71], v[64:67], v[16:31]
    ds_read_b64_tr_b16 v[56:57], v252 offset:10880
    ds_read_b64_tr_b16 v[58:59], v252 offset:11040
    ds_read_b128 v[60:63], v113 offset:17408
    s_waitcnt lgkmcnt(6)
    v_mfma_f32_32x32x16_bf16 v[16:31], v[76:79], v[72:75], v[16:31]
    ds_read_b64_tr_b16 v[64:65], v252 offset:11520
    ds_read_b64_tr_b16 v[66:67], v252 offset:11680
    ds_read_b128 v[68:71], v114 offset:18432
    s_waitcnt lgkmcnt(6)
    v_mfma_f32_32x32x16_bf16 v[16:31], v[52:55], v[48:51], v[16:31]
    ds_read_b64_tr_b16 v[72:73], v252 offset:12160
    ds_read_b64_tr_b16 v[74:75], v252 offset:12320
    ds_read_b128 v[76:79], v115 offset:19456
    s_waitcnt lgkmcnt(6)
    v_mfma_f32_32x32x16_bf16 v[16:31], v[60:63], v[56:59], v[16:31]
    ds_read_b64_tr_b16 v[48:49], v252 offset:12800
    ds_read_b64_tr_b16 v[50:51], v252 offset:12960
    ds_read_b128 v[52:55], v112 offset:20480
    s_waitcnt lgkmcnt(6)
    v_mfma_f32_32x32x16_bf16 v[16:31], v[68:71], v[64:67], v[16:31]
    ds_read_b64_tr_b16 v[56:57], v252 offset:13440
    ds_read_b64_tr_b16 v[58:59], v252 offset:13600
    ds_read_b128 v[60:63], v113 offset:21504
    s_waitcnt lgkmcnt(6)
    v_mfma_f32_32x32x16_bf16 v[16:31], v[76:79], v[72:75], v[16:31]
    ds_read_b64_tr_b16 v[64:65], v252 offset:14080
    ds_read_b64_tr_b16 v[66:67], v252 offset:14240
    ds_read_b128 v[68:71], v114 offset:22528
    s_waitcnt lgkmcnt(6)
    v_mfma_f32_32x32x16_bf16 v[16:31], v[52:55], v[48:51], v[16:31]
    ds_read_b64_tr_b16 v[72:73], v252 offset:14720
    ds_read_b64_tr_b16 v[74:75], v252 offset:14880
    ds_read_b128 v[76:79], v115 offset:23552
    s_waitcnt lgkmcnt(6)
    v_mfma_f32_32x32x16_bf16 v[16:31], v[60:63], v[56:59], v[16:31]
    ds_read_b64_tr_b16 v[48:49], v252 offset:15360
    ds_read_b64_tr_b16 v[50:51], v252 offset:15520
    ds_read_b128 v[52:55], v112 offset:24576
    s_waitcnt lgkmcnt(6)
    v_mfma_f32_32x32x16_bf16 v[16:31], v[68:71], v[64:67], v[16:31]
    ds_read_b64_tr_b16 v[56:57], v252 offset:16000
    ds_read_b64_tr_b16 v[58:59], v252 offset:16160
    ds_read_b128 v[60:63], v113 offset:25600
    s_waitcnt lgkmcnt(6)
    v_mfma_f32_32x32x16_bf16 v[16:31], v[76:79], v[72:75], v[16:31]
    ds_read_b64_tr_b16 v[64:65], v252 offset:16640
    ds_read_b64_tr_b16 v[66:67], v252 offset:16800
    ds_read_b128 v[68:71], v114 offset:26624
    s_waitcnt lgkmcnt(6)
    v_mfma_f32_32x32x16_bf16 v[16:31], v[52:55], v[48:51], v[16:31]
    ds_read_b64_tr_b16 v[72:73], v252 offset:17280
    ds_read_b64_tr_b16 v[74:75], v252 offset:17440
    ds_read_b128 v[76:79], v115 offset:27648
    s_waitcnt lgkmcnt(6)
    v_mfma_f32_32x32x16_bf16 v[16:31], v[60:63], v[56:59], v[16:31]
    ds_read_b64_tr_b16 v[48:49], v252 offset:17920
    ds_read_b64_tr_b16 v[50:51], v252 offset:18080
    ds_read_b128 v[52:55], v112 offset:28672
    s_waitcnt lgkmcnt(6)
    v_mfma_f32_32x32x16_bf16 v[16:31], v[68:71], v[64:67], v[16:31]
    ds_read_b64_tr_b16 v[56:57], v252 offset:18560
    ds_read_b64_tr_b16 v[58:59], v252 offset:18720
    ds_read_b128 v[60:63], v113 offset:29696
    s_waitcnt lgkmcnt(6)
    v_mfma_f32_32x32x16_bf16 v[16:31], v[76:79], v[72:75], v[16:31]
    ds_read_b64_tr_b16 v[64:65], v252 offset:19200
    ds_read_b64_tr_b16 v[66:67], v252 offset:19360
    ds_read_b128 v[68:71], v114 offset:30720
    s_waitcnt lgkmcnt(6)
    v_mfma_f32_32x32x16_bf16 v[16:31], v[52:55], v[48:51], v[16:31]
    ds_read_b64_tr_b16 v[72:73], v252 offset:19840
    ds_read_b64_tr_b16 v[74:75], v252 offset:20000
    ds_read_b128 v[76:79], v115 offset:31744
    s_waitcnt lgkmcnt(6)
    v_mfma_f32_32x32x16_bf16 v[16:31], v[60:63], v[56:59], v[16:31]
    ds_read_b64_tr_b16 v[48:49], v252 offset:20480
    ds_read_b64_tr_b16 v[50:51], v252 offset:20640
    ds_read_b128 v[52:55], v112 offset:32768
    s_waitcnt lgkmcnt(6)
    v_mfma_f32_32x32x16_bf16 v[16:31], v[68:71], v[64:67], v[16:31]
    ds_read_b64_tr_b16 v[56:57], v252 offset:21120
    ds_read_b64_tr_b16 v[58:59], v252 offset:21280
    ds_read_b128 v[60:63], v113 offset:33792
    s_waitcnt lgkmcnt(6)
    v_mfma_f32_32x32x16_bf16 v[16:31], v[76:79], v[72:75], v[16:31]
    ds_read_b64_tr_b16 v[64:65], v252 offset:21760
    ds_read_b64_tr_b16 v[66:67], v252 offset:21920
    ds_read_b128 v[68:71], v114 offset:34816
    s_waitcnt lgkmcnt(6)
    v_mfma_f32_32x32x16_bf16 v[16:31], v[52:55], v[48:51], v[16:31]
    ds_read_b64_tr_b16 v[72:73], v252 offset:22400
    ds_read_b64_tr_b16 v[74:75], v252 offset:22560
    ds_read_b128 v[76:79], v115 offset:35840
    s_waitcnt lgkmcnt(6)
    v_mfma_f32_32x32x16_bf16 v[16:31], v[60:63], v[56:59], v[16:31]
    ds_read_b64_tr_b16 v[48:49], v252 offset:23040
    ds_read_b64_tr_b16 v[50:51], v252 offset:23200
    ds_read_b128 v[52:55], v112 offset:36864
    s_waitcnt lgkmcnt(6)
    v_mfma_f32_32x32x16_bf16 v[16:31], v[68:71], v[64:67], v[16:31]
    ds_read_b64_tr_b16 v[56:57], v252 offset:23680
    ds_read_b64_tr_b16 v[58:59], v252 offset:23840
    ds_read_b128 v[60:63], v113 offset:37888
    s_waitcnt lgkmcnt(6)
    v_mfma_f32_32x32x16_bf16 v[16:31], v[76:79], v[72:75], v[16:31]
    ds_read_b64_tr_b16 v[64:65], v252 offset:24320
    ds_read_b64_tr_b16 v[66:67], v252 offset:24480
    ds_read_b128 v[68:71], v114 offset:38912
    s_waitcnt lgkmcnt(6)
    v_mfma_f32_32x32x16_bf16 v[16:31], v[52:55], v[48:51], v[16:31]
    ds_read_b64_tr_b16 v[72:73], v252 offset:24960
    ds_read_b64_tr_b16 v[74:75], v252 offset:25120
    ds_read_b128 v[76:79], v115 offset:39936
    s_waitcnt lgkmcnt(6)
    v_mfma_f32_32x32x16_bf16 v[16:31], v[60:63], v[56:59], v[16:31]
    s_waitcnt lgkmcnt(3)
    v_mfma_f32_32x32x16_bf16 v[16:31], v[68:71], v[64:67], v[16:31]
    s_waitcnt lgkmcnt(0)
    v_mfma_f32_32x32x16_bf16 v[16:31], v[76:79], v[72:75], v[16:31]
    s_lshr_b32 s62, s4, 1
    s_mul_i32 s62, s62, 12288
    s_add_u32 s62, s62, 65536
    s_and_b32 s63, s4, 1
    s_lshl_b32 s65, s63, 1
    s_add_u32 s65, s65, s7
    v_and_b32 v93, 31, v0
    v_lshrrev_b32 v95, 5, v0
    v_mul_u32_u24 v95, 352, v95
    v_lshl_add_u32 v95, v93, 4, v95
    s_lshl_b32 s65, s65, 1
    s_mul_i32 s65, s65, 704
    s_add_u32 s62, s62, s65
    s_add_u32 s62, s62, 5120
    v_cmp_eq_u32 vcc, 20, v93
    v_cmp_eq_u32 s[64:65], 21, v93
    v_mov_b32 v94, 0x3f803f80
    v_mov_b32 v98, 0
    v_cvt_pk_bf16_f32 v80, v16, v17
    v_cvt_pk_bf16_f32 v81, v18, v19
    v_cvt_pk_bf16_f32 v82, v20, v21
    v_cvt_pk_bf16_f32 v83, v22, v23
    v_cvt_pk_bf16_f32 v84, v24, v25
    v_cvt_pk_bf16_f32 v85, v26, v27
    v_cvt_pk_bf16_f32 v86, v28, v29
    v_cvt_pk_bf16_f32 v87, v30, v31
    v_cndmask_b32 v80, v80, v94, vcc
    v_cndmask_b32 v81, v81, v94, vcc
    v_cndmask_b32 v82, v82, v94, vcc
    v_cndmask_b32 v83, v83, v94, vcc
    v_cndmask_b32 v84, v84, v94, vcc
    v_cndmask_b32 v85, v85, v94, vcc
    v_cndmask_b32 v86, v86, v94, vcc
    v_cndmask_b32 v87, v87, v94, vcc
    v_cndmask_b32 v80, v80, v98, s[64:65]
    v_cndmask_b32 v81, v81, v98, s[64:65]
    v_cndmask_b32 v82, v82, v98, s[64:65]
    v_cndmask_b32 v83, v83, v98, s[64:65]
    v_cndmask_b32 v84, v84, v98, s[64:65]
    v_cndmask_b32 v85, v85, v98, s[64:65]
    v_cndmask_b32 v86, v86, v98, s[64:65]
    v_cndmask_b32 v87, v87, v98, s[64:65]
    s_mov_b32 exec_lo, 0x3fffff
    s_mov_b32 exec_hi, 0x3fffff
    buffer_store_dwordx4 v[80:83], v95, s[36:39], s62 offen sc1
    buffer_store_dwordx4 v[84:87], v95, s[36:39], s62 offen offset:704 sc1
    s_mov_b64 exec, -1
    v_max3_f32 v92, abs(v16), abs(v17), abs(v18)
    v_max3_f32 v92, v92, abs(v19), abs(v20)
    v_max3_f32 v92, v92, abs(v21), abs(v22)
    v_max3_f32 v92, v92, abs(v23), abs(v24)
    v_max3_f32 v92, v92, abs(v25), abs(v26)
    v_max3_f32 v92, v92, abs(v27), abs(v28)
    v_max3_f32 v92, v92, abs(v29), abs(v30)
    v_max3_f32 v92, v92, abs(v31), abs(v31)
    v_cmp_gt_u32 vcc, 20, v93
    s_nop 1
    v_cndmask_b32 v92, 0, v92, vcc
    s_nop 1
    v_max_f32_dpp v92, v92, v92 row_shr:1 row_mask:0xf bank_mask:0xf
    s_nop 1
    v_max_f32_dpp v92, v92, v92 row_shr:2 row_mask:0xf bank_mask:0xf
    s_nop 1
    v_max_f32_dpp v92, v92, v92 row_shr:4 row_mask:0xf bank_mask:0xf
    s_nop 1
    v_max_f32_dpp v92, v92, v92 row_shr:8 row_mask:0xf bank_mask:0xf
    s_nop 1
    v_max_f32_dpp v92, v92, v92 row_bcast:15 row_mask:0xa bank_mask:0xf
    s_nop 1
    v_max_f32_dpp v92, v92, v92 row_bcast:31 row_mask:0xc bank_mask:0xf
    s_nop 0
    v_readlane_b32 s63, v92, 63
    s_lshl_b32 s62, s4, 1
    s_add_u32 s62, s62, s7
    s_lshl_b32 s62, s62, 2
    s_add_u32 s62, s62, 33792
    v_mov_b32 v92, s63
    v_mov_b32 v93, 0
    s_mov_b64 exec, 1
    buffer_store_dword v92, v93, s[36:39], s62 offen sc1
    s_mov_b64 exec, -1
    s_waitcnt vmcnt(0)
    ds_add_rtn_u32 v248, v242, v244 offset:4
    s_waitcnt lgkmcnt(0)
    v_readfirstlane_b32 s62, v248
    s_nop 0
    s_cmp_lg_u32 s62, 1
    s_cbranch_scc1 L_kvnf_46
    v_lshlrev_b32 v92, 8, v0
    v_mov_b32 v93, s6
    s_lshl_b32 s62, s4, 1
    s_add_u32 s62, s62, 1
    s_lshl_b32 s62, s62, 2
    s_add_u32 s62, s62, 4096
    s_mov_b32 exec_lo, -1
    s_mov_b32 exec_hi, 0
    buffer_store_dword v93, v92, s[36:39], s62 offen sc1
    s_mov_b64 exec, -1
L_kvnf_46:
L_kvidle_44:
    s_mov_b32 s62, 0
L_spin_47:
    ds_read_b32 v246, v243 offset:4
    s_waitcnt lgkmcnt(0)
    v_cmp_gt_u32 vcc, 2, v246
    s_cbranch_vccz L_spind_48
    s_add_u32 s62, s62, 1
    s_cmp_lt_u32 s62, 400000
    s_sleep 1
    s_cbranch_scc1 L_spin_47
L_spind_48:
L_w1pf_43:
L_ffn1_41:
    s_setprio 0
    s_cmp_eq_u32 s99, 0
    s_cbranch_scc1 L_nopair_49
    s_add_u32 m0, s66, 0
    s_nop 0
    buffer_load_dwordx4 v230, s[24:27], s67 offen lds
    buffer_load_dwordx4 v231, s[24:27], s67 offen offset:1024 lds
    s_add_u32 s67, s67, 55296
    s_add_u32 m0, s66, 2048
    s_nop 0
    buffer_load_dwordx4 v230, s[24:27], s67 offen lds
    buffer_load_dwordx4 v231, s[24:27], s67 offen offset:1024 lds
    s_add_u32 s67, s67, 55296
    s_add_u32 m0, s66, 4096
    s_nop 0
    buffer_load_dwordx4 v230, s[24:27], s67 offen lds
    buffer_load_dwordx4 v231, s[24:27], s67 offen offset:1024 lds
    s_add_u32 s67, s67, 55296
    s_add_u32 m0, s66, 6144
    s_nop 0
    buffer_load_dwordx4 v230, s[24:27], s67 offen lds
    buffer_load_dwordx4 v231, s[24:27], s67 offen offset:1024 lds
    s_add_u32 s67, s67, 55296
    s_waitcnt vmcnt(6)
    ds_read_b64_tr_b16 v[80:81], v232 offset:0
    ds_read_b64_tr_b16 v[82:83], v232 offset:512
    ds_read_b128 v[96:99], v234 offset:0
    ds_read_b128 v[100:103], v238 offset:0
    ds_read_b64_tr_b16 v[84:85], v233 offset:0
    ds_read_b64_tr_b16 v[86:87], v233 offset:512
    s_waitcnt lgkmcnt(2)
    v_mfma_f32_32x32x16_bf16 v[16:31], v[80:83], v[96:99], 0
    s_waitcnt vmcnt(4)
    ds_read_b64_tr_b16 v[88:89], v232 offset:2048
    ds_read_b64_tr_b16 v[90:91], v232 offset:2560
    v_mfma_f32_32x32x16_bf16 v[32:47], v[80:83], v[100:103], 0
    s_waitcnt lgkmcnt(2)
    ds_read_b128 v[104:107], v235 offset:1024
    ds_read_b128 v[108:111], v239 offset:1024
    s_add_u32 m0, s66, 0
    v_mfma_f32_32x32x16_bf16 v[48:63], v[84:87], v[96:99], 0
    ds_read_b64_tr_b16 v[92:93], v233 offset:2048
    ds_read_b64_tr_b16 v[94:95], v233 offset:2560
    buffer_load_dwordx4 v230, s[24:27], s67 offen lds
    v_mfma_f32_32x32x16_bf16 v[64:79], v[84:87], v[100:103], 0
    buffer_load_dwordx4 v231, s[24:27], s67 offen offset:1024 lds
    s_add_u32 s67, s67, 55296
    s_waitcnt lgkmcnt(2)
    v_mfma_f32_32x32x16_bf16 v[16:31], v[88:91], v[104:107], v[16:31]
    s_waitcnt vmcnt(4)
    ds_read_b64_tr_b16 v[80:81], v232 offset:4096
    ds_read_b64_tr_b16 v[82:83], v232 offset:4608
    v_mfma_f32_32x32x16_bf16 v[32:47], v[88:91], v[108:111], v[32:47]
    s_waitcnt lgkmcnt(2)
    ds_read_b128 v[96:99], v236 offset:2048
    ds_read_b128 v[100:103], v240 offset:2048
    s_add_u32 m0, s66, 2048
    v_mfma_f32_32x32x16_bf16 v[48:63], v[92:95], v[104:107], v[48:63]
    ds_read_b64_tr_b16 v[84:85], v233 offset:4096
    ds_read_b64_tr_b16 v[86:87], v233 offset:4608
    buffer_load_dwordx4 v230, s[24:27], s67 offen lds
    v_mfma_f32_32x32x16_bf16 v[64:79], v[92:95], v[108:111], v[64:79]
    buffer_load_dwordx4 v231, s[24:27], s67 offen offset:1024 lds
    s_add_u32 s67, s67, 55296
    s_waitcnt lgkmcnt(2)
    v_mfma_f32_32x32x16_bf16 v[16:31], v[80:83], v[96:99], v[16:31]
    s_waitcnt vmcnt(4)
    ds_read_b64_tr_b16 v[88:89], v232 offset:6144
    ds_read_b64_tr_b16 v[90:91], v232 offset:6656
    v_mfma_f32_32x32x16_bf16 v[32:47], v[80:83], v[100:103], v[32:47]
    s_waitcnt lgkmcnt(2)
    ds_read_b128 v[104:107], v237 offset:3072
    ds_read_b128 v[108:111], v241 offset:3072
    s_add_u32 m0, s66, 4096
    v_mfma_f32_32x32x16_bf16 v[48:63], v[84:87], v[96:99], v[48:63]
    ds_read_b64_tr_b16 v[92:93], v233 offset:6144
    ds_read_b64_tr_b16 v[94:95], v233 offset:6656
    buffer_load_dwordx4 v230, s[24:27], s67 offen lds
    v_mfma_f32_32x32x16_bf16 v[64:79], v[84:87], v[100:103], v[64:79]
    buffer_load_dwordx4 v231, s[24:27], s67 offen offset:1024 lds
    s_add_u32 s67, s67, 55296
    s_waitcnt lgkmcnt(2)
    v_mfma_f32_32x32x16_bf16 v[16:31], v[88:91], v[104:107], v[16:31]
    s_waitcnt vmcnt(4)
    ds_read_b64_tr_b16 v[80:81], v232 offset:0
    ds_read_b64_tr_b16 v[82:83], v232 offset:512
    v_mfma_f32_32x32x16_bf16 v[32:47], v[88:91], v[108:111], v[32:47]
    s_waitcnt lgkmcnt(2)
    ds_read_b128 v[96:99], v234 offset:4096
    ds_read_b128 v[100:103], v238 offset:4096
    s_add_u32 m0, s66, 6144
    v_mfma_f32_32x32x16_bf16 v[48:63], v[92:95], v[104:107], v[48:63]
    ds_read_b64_tr_b16 v[84:85], v233 offset:0
    ds_read_b64_tr_b16 v[86:87], v233 offset:512
    buffer_load_dwordx4 v230, s[24:27], s67 offen lds
    v_mfma_f32_32x32x16_bf16 v[64:79], v[92:95], v[108:111], v[64:79]
    buffer_load_dwordx4 v231, s[24:27], s67 offen offset:1024 lds
    s_add_u32 s67, s67, 55296
    s_cmp_eq_u32 s67, 2211840
    s_cselect_b32 s67, 0, s67
    s_waitcnt lgkmcnt(2)
    v_mfma_f32_32x32x16_bf16 v[16:31], v[80:83], v[96:99], v[16:31]
    s_waitcnt vmcnt(4)
    ds_read_b64_tr_b16 v[88:89], v232 offset:2048
    ds_read_b64_tr_b16 v[90:91], v232 offset:2560
    v_mfma_f32_32x32x16_bf16 v[32:47], v[80:83], v[100:103], v[32:47]
    s_waitcnt lgkmcnt(2)
    ds_read_b128 v[104:107], v235 offset:5120
    ds_read_b128 v[108:111], v239 offset:5120
    s_add_u32 m0, s66, 0
    v_mfma_f32_32x32x16_bf16 v[48:63], v[84:87], v[96:99], v[48:63]
    ds_read_b64_tr_b16 v[92:93], v233 offset:2048
    ds_read_b64_tr_b16 v[94:95], v233 offset:2560
    buffer_load_dwordx4 v230, s[24:27], s67 offen lds
    v_mfma_f32_32x32x16_bf16 v[64:79], v[84:87], v[100:103], v[64:79]
    buffer_load_dwordx4 v231, s[24:27], s67 offen offset:1024 lds
    s_add_u32 s67, s67, 55296
    s_waitcnt lgkmcnt(2)
    v_mfma_f32_32x32x16_bf16 v[16:31], v[88:91], v[104:107], v[16:31]
    s_waitcnt vmcnt(4)
    ds_read_b64_tr_b16 v[80:81], v232 offset:4096
    ds_read_b64_tr_b16 v[82:83], v232 offset:4608
    v_mfma_f32_32x32x16_bf16 v[32:47], v[88:91], v[108:111], v[32:47]
    s_waitcnt lgkmcnt(2)
    ds_read_b128 v[96:99], v236 offset:6144
    ds_read_b128 v[100:103], v240 offset:6144
    s_add_u32 m0, s66, 2048
    v_mfma_f32_32x32x16_bf16 v[48:63], v[92:95], v[104:107], v[48:63]
    ds_read_b64_tr_b16 v[84:85], v233 offset:4096
    ds_read_b64_tr_b16 v[86:87], v233 offset:4608
    buffer_load_dwordx4 v230, s[24:27], s67 offen lds
    v_mfma_f32_32x32x16_bf16 v[64:79], v[92:95], v[108:111], v[64:79]
    buffer_load_dwordx4 v231, s[24:27], s67 offen offset:1024 lds
    s_add_u32 s67, s67, 55296
    s_waitcnt lgkmcnt(2)
    v_mfma_f32_32x32x16_bf16 v[16:31], v[80:83], v[96:99], v[16:31]
    s_waitcnt vmcnt(4)
    ds_read_b64_tr_b16 v[88:89], v232 offset:6144
    ds_read_b64_tr_b16 v[90:91], v232 offset:6656
    v_mfma_f32_32x32x16_bf16 v[32:47], v[80:83], v[100:103], v[32:47]
    s_waitcnt lgkmcnt(2)
    ds_read_b128 v[104:107], v237 offset:7168
    ds_read_b128 v[108:111], v241 offset:7168
    s_add_u32 m0, s66, 4096
    v_mfma_f32_32x32x16_bf16 v[48:63], v[84:87], v[96:99], v[48:63]
    ds_read_b64_tr_b16 v[92:93], v233 offset:6144
    ds_read_b64_tr_b16 v[94:95], v233 offset:6656
    buffer_load_dwordx4 v230, s[24:27], s67 offen lds
    v_mfma_f32_32x32x16_bf16 v[64:79], v[84:87], v[100:103], v[64:79]
    buffer_load_dwordx4 v231, s[24:27], s67 offen offset:1024 lds
    s_add_u32 s67, s67, 55296
    s_waitcnt lgkmcnt(2)
    v_mfma_f32_32x32x16_bf16 v[16:31], v[88:91], v[104:107], v[16:31]
    s_waitcnt vmcnt(4)
    ds_read_b64_tr_b16 v[80:81], v232 offset:0
    ds_read_b64_tr_b16 v[82:83], v232 offset:512
    v_mfma_f32_32x32x16_bf16 v[32:47], v[88:91], v[108:111], v[32:47]
    s_waitcnt lgkmcnt(2)
    s_cmp_eq_u32 s69, 32
    s_cbranch_scc0 L_wrap_51
    v_subrev_u32 v234, 40960, v234
    v_subrev_u32 v238, 40960, v238
    v_subrev_u32 v235, 40960, v235
    v_subrev_u32 v239, 40960, v239
    v_subrev_u32 v236, 40960, v236
    v_subrev_u32 v240, 40960, v240
    v_subrev_u32 v237, 40960, v237
    v_subrev_u32 v241, 40960, v241
L_wrap_51:
    ds_read_b128 v[96:99], v234 offset:8192
    ds_read_b128 v[100:103], v238 offset:8192
    s_add_u32 m0, s66, 6144
    v_mfma_f32_32x32x16_bf16 v[48:63], v[92:95], v[104:107], v[48:63]
    ds_read_b64_tr_b16 v[84:85], v233 offset:0
    ds_read_b64_tr_b16 v[86:87], v233 offset:512
    buffer_load_dwordx4 v230, s[24:27], s67 offen lds
    v_mfma_f32_32x32x16_bf16 v[64:79], v[92:95], v[108:111], v[64:79]
    buffer_load_dwordx4 v231, s[24:27], s67 offen offset:1024 lds
    s_add_u32 s67, s67, 55296
    s_cmp_eq_u32 s67, 2211840
    s_cselect_b32 s67, 0, s67
    s_waitcnt lgkmcnt(2)
    v_mfma_f32_32x32x16_bf16 v[16:31], v[80:83], v[96:99], v[16:31]
    s_waitcnt vmcnt(4)
    ds_read_b64_tr_b16 v[88:89], v232 offset:2048
    ds_read_b64_tr_b16 v[90:91], v232 offset:2560
    v_mfma_f32_32x32x16_bf16 v[32:47], v[80:83], v[100:103], v[32:47]
    s_waitcnt lgkmcnt(2)
    ds_read_b128 v[104:107], v235 offset:9216
    ds_read_b128 v[108:111], v239 offset:9216
    s_add_u32 m0, s66, 0
    v_mfma_f32_32x32x16_bf16 v[48:63], v[84:87], v[96:99], v[48:63]
    ds_read_b64_tr_b16 v[92:93], v233 offset:2048
    ds_read_b64_tr_b16 v[94:95], v233 offset:2560
    buffer_load_dwordx4 v230, s[24:27], s67 offen lds
    v_mfma_f32_32x32x16_bf16 v[64:79], v[84:87], v[100:103], v[64:79]
    buffer_load_dwordx4 v231, s[24:27], s67 offen offset:1024 lds
    s_add_u32 s67, s67, 55296
    s_waitcnt lgkmcnt(2)
    v_mfma_f32_32x32x16_bf16 v[16:31], v[88:91], v[104:107], v[16:31]
    s_waitcnt vmcnt(4)
    ds_read_b64_tr_b16 v[80:81], v232 offset:4096
    ds_read_b64_tr_b16 v[82:83], v232 offset:4608
    v_mfma_f32_32x32x16_bf16 v[32:47], v[88:91], v[108:111], v[32:47]
    s_waitcnt lgkmcnt(2)
    ds_read_b128 v[96:99], v236 offset:10240
    ds_read_b128 v[100:103], v240 offset:10240
    s_add_u32 m0, s66, 2048
    v_mfma_f32_32x32x16_bf16 v[48:63], v[92:95], v[104:107], v[48:63]
    ds_read_b64_tr_b16 v[84:85], v233 offset:4096
    ds_read_b64_tr_b16 v[86:87], v233 offset:4608
    buffer_load_dwordx4 v230, s[24:27], s67 offen lds
    v_mfma_f32_32x32x16_bf16 v[64:79], v[92:95], v[108:111], v[64:79]
    buffer_load_dwordx4 v231, s[24:27], s67 offen offset:1024 lds
    s_add_u32 s67, s67, 55296
    s_waitcnt lgkmcnt(2)
    v_mfma_f32_32x32x16_bf16 v[16:31], v[80:83], v[96:99], v[16:31]
    s_waitcnt vmcnt(4)
    ds_read_b64_tr_b16 v[88:89], v232 offset:6144
    ds_read_b64_tr_b16 v[90:91], v232 offset:6656
    v_mfma_f32_32x32x16_bf16 v[32:47], v[80:83], v[100:103], v[32:47]
    s_waitcnt lgkmcnt(2)
    ds_read_b128 v[104:107], v237 offset:11264
    ds_read_b128 v[108:111], v241 offset:11264
    s_add_u32 m0, s66, 4096
    v_mfma_f32_32x32x16_bf16 v[48:63], v[84:87], v[96:99], v[48:63]
    ds_read_b64_tr_b16 v[92:93], v233 offset:6144
    ds_read_b64_tr_b16 v[94:95], v233 offset:6656
    buffer_load_dwordx4 v230, s[24:27], s67 offen lds
    v_mfma_f32_32x32x16_bf16 v[64:79], v[84:87], v[100:103], v[64:79]
    buffer_load_dwordx4 v231, s[24:27], s67 offen offset:1024 lds
    s_add_u32 s67, s67, 55296
    s_waitcnt lgkmcnt(2)
    v_mfma_f32_32x32x16_bf16 v[16:31], v[88:91], v[104:107], v[16:31]
    s_waitcnt vmcnt(4)
    ds_read_b64_tr_b16 v[80:81], v232 offset:0
    ds_read_b64_tr_b16 v[82:83], v232 offset:512
    v_mfma_f32_32x32x16_bf16 v[32:47], v[88:91], v[108:111], v[32:47]
    s_waitcnt lgkmcnt(2)
    s_cmp_eq_u32 s69, 28
    s_cbranch_scc0 L_wrap_52
    v_subrev_u32 v234, 40960, v234
    v_subrev_u32 v238, 40960, v238
    v_subrev_u32 v235, 40960, v235
    v_subrev_u32 v239, 40960, v239
    v_subrev_u32 v236, 40960, v236
    v_subrev_u32 v240, 40960, v240
    v_subrev_u32 v237, 40960, v237
    v_subrev_u32 v241, 40960, v241
L_wrap_52:
    ds_read_b128 v[96:99], v234 offset:12288
    ds_read_b128 v[100:103], v238 offset:12288
    s_add_u32 m0, s66, 6144
    v_mfma_f32_32x32x16_bf16 v[48:63], v[92:95], v[104:107], v[48:63]
    ds_read_b64_tr_b16 v[84:85], v233 offset:0
    ds_read_b64_tr_b16 v[86:87], v233 offset:512
    buffer_load_dwordx4 v230, s[24:27], s67 offen lds
    v_mfma_f32_32x32x16_bf16 v[64:79], v[92:95], v[108:111], v[64:79]
    buffer_load_dwordx4 v231, s[24:27], s67 offen offset:1024 lds
    s_add_u32 s67, s67, 55296
    s_cmp_eq_u32 s67, 2211840
    s_cselect_b32 s67, 0, s67
    s_waitcnt lgkmcnt(2)
    v_mfma_f32_32x32x16_bf16 v[16:31], v[80:83], v[96:99], v[16:31]
    s_waitcnt vmcnt(4)
    ds_read_b64_tr_b16 v[88:89], v232 offset:2048
    ds_read_b64_tr_b16 v[90:91], v232 offset:2560
    v_mfma_f32_32x32x16_bf16 v[32:47], v[80:83], v[100:103], v[32:47]
    s_waitcnt lgkmcnt(2)
    ds_read_b128 v[104:107], v235 offset:13312
    ds_read_b128 v[108:111], v239 offset:13312
    s_add_u32 m0, s66, 0
    v_mfma_f32_32x32x16_bf16 v[48:63], v[84:87], v[96:99], v[48:63]
    ds_read_b64_tr_b16 v[92:93], v233 offset:2048
    ds_read_b64_tr_b16 v[94:95], v233 offset:2560
    buffer_load_dwordx4 v230, s[24:27], s67 offen lds
    v_mfma_f32_32x32x16_bf16 v[64:79], v[84:87], v[100:103], v[64:79]
    buffer_load_dwordx4 v231, s[24:27], s67 offen offset:1024 lds
    s_add_u32 s67, s67, 55296
    s_waitcnt lgkmcnt(2)
    v_mfma_f32_32x32x16_bf16 v[16:31], v[88:91], v[104:107], v[16:31]
    s_waitcnt vmcnt(4)
    ds_read_b64_tr_b16 v[80:81], v232 offset:4096
    ds_read_b64_tr_b16 v[82:83], v232 offset:4608
    v_mfma_f32_32x32x16_bf16 v[32:47], v[88:91], v[108:111], v[32:47]
    s_waitcnt lgkmcnt(2)
    ds_read_b128 v[96:99], v236 offset:14336
    ds_read_b128 v[100:103], v240 offset:14336
    s_add_u32 m0, s66, 2048
    v_mfma_f32_32x32x16_bf16 v[48:63], v[92:95], v[104:107], v[48:63]
    ds_read_b64_tr_b16 v[84:85], v233 offset:4096
    ds_read_b64_tr_b16 v[86:87], v233 offset:4608
    buffer_load_dwordx4 v230, s[24:27], s67 offen lds
    v_mfma_f32_32x32x16_bf16 v[64:79], v[92:95], v[108:111], v[64:79]
    buffer_load_dwordx4 v231, s[24:27], s67 offen offset:1024 lds
    s_add_u32 s67, s67, 55296
    s_waitcnt lgkmcnt(2)
    v_mfma_f32_32x32x16_bf16 v[16:31], v[80:83], v[96:99], v[16:31]
    s_waitcnt vmcnt(4)
    ds_read_b64_tr_b16 v[88:89], v232 offset:6144
    ds_read_b64_tr_b16 v[90:91], v232 offset:6656
    v_mfma_f32_32x32x16_bf16 v[32:47], v[80:83], v[100:103], v[32:47]
    s_waitcnt lgkmcnt(2)
    ds_read_b128 v[104:107], v237 offset:15360
    ds_read_b128 v[108:111], v241 offset:15360
    s_add_u32 m0, s66, 4096
    v_mfma_f32_32x32x16_bf16 v[48:63], v[84:87], v[96:99], v[48:63]
    ds_read_b64_tr_b16 v[92:93], v233 offset:6144
    ds_read_b64_tr_b16 v[94:95], v233 offset:6656
    buffer_load_dwordx4 v230, s[24:27], s67 offen lds
    v_mfma_f32_32x32x16_bf16 v[64:79], v[84:87], v[100:103], v[64:79]
    buffer_load_dwordx4 v231, s[24:27], s67 offen offset:1024 lds
    s_add_u32 s67, s67, 55296
    s_waitcnt lgkmcnt(2)
    v_mfma_f32_32x32x16_bf16 v[16:31], v[88:91], v[104:107], v[16:31]
    s_waitcnt vmcnt(4)
    ds_read_b64_tr_b16 v[80:81], v232 offset:0
    ds_read_b64_tr_b16 v[82:83], v232 offset:512
    v_mfma_f32_32x32x16_bf16 v[32:47], v[88:91], v[108:111], v[32:47]
    s_waitcnt lgkmcnt(2)
    s_cmp_eq_u32 s69, 24
    s_cbranch_scc0 L_wrap_53
    v_subrev_u32 v234, 40960, v234
    v_subrev_u32 v238, 40960, v238
    v_subrev_u32 v235, 40960, v235
    v_subrev_u32 v239, 40960, v239
    v_subrev_u32 v236, 40960, v236
    v_subrev_u32 v240, 40960, v240
    v_subrev_u32 v237, 40960, v237
    v_subrev_u32 v241, 40960, v241
L_wrap_53:
    ds_read_b128 v[96:99], v234 offset:16384
    ds_read_b128 v[100:103], v238 offset:16384
    s_add_u32 m0, s66, 6144
    v_mfma_f32_32x32x16_bf16 v[48:63], v[92:95], v[104:107], v[48:63]
    ds_read_b64_tr_b16 v[84:85], v233 offset:0
    ds_read_b64_tr_b16 v[86:87], v233 offset:512
    buffer_load_dwordx4 v230, s[24:27], s67 offen lds
    v_mfma_f32_32x32x16_bf16 v[64:79], v[92:95], v[108:111], v[64:79]
    buffer_load_dwordx4 v231, s[24:27], s67 offen offset:1024 lds
    s_add_u32 s67, s67, 55296
    s_cmp_eq_u32 s67, 2211840
    s_cselect_b32 s67, 0, s67
    s_waitcnt lgkmcnt(2)
    v_mfma_f32_32x32x16_bf16 v[16:31], v[80:83], v[96:99], v[16:31]
    s_waitcnt vmcnt(4)
    ds_read_b64_tr_b16 v[88:89], v232 offset:2048
    ds_read_b64_tr_b16 v[90:91], v232 offset:2560
    v_mfma_f32_32x32x16_bf16 v[32:47], v[80:83], v[100:103], v[32:47]
    s_waitcnt lgkmcnt(2)
    ds_read_b128 v[104:107], v235 offset:17408
    ds_read_b128 v[108:111], v239 offset:17408
    s_add_u32 m0, s66, 0
    v_mfma_f32_32x32x16_bf16 v[48:63], v[84:87], v[96:99], v[48:63]
    ds_read_b64_tr_b16 v[92:93], v233 offset:2048
    ds_read_b64_tr_b16 v[94:95], v233 offset:2560
    buffer_load_dwordx4 v230, s[24:27], s67 offen lds
    v_mfma_f32_32x32x16_bf16 v[64:79], v[84:87], v[100:103], v[64:79]
    buffer_load_dwordx4 v231, s[24:27], s67 offen offset:1024 lds
    s_add_u32 s67, s67, 55296
    s_waitcnt lgkmcnt(2)
    v_mfma_f32_32x32x16_bf16 v[16:31], v[88:91], v[104:107], v[16:31]
    s_waitcnt vmcnt(4)
    ds_read_b64_tr_b16 v[80:81], v232 offset:4096
    ds_read_b64_tr_b16 v[82:83], v232 offset:4608
    v_mfma_f32_32x32x16_bf16 v[32:47], v[88:91], v[108:111], v[32:47]
    s_waitcnt lgkmcnt(2)
    ds_read_b128 v[96:99], v236 offset:18432
    ds_read_b128 v[100:103], v240 offset:18432
    s_add_u32 m0, s66, 2048
    v_mfma_f32_32x32x16_bf16 v[48:63], v[92:95], v[104:107], v[48:63]
    ds_read_b64_tr_b16 v[84:85], v233 offset:4096
    ds_read_b64_tr_b16 v[86:87], v233 offset:4608
    buffer_load_dwordx4 v230, s[24:27], s67 offen lds
    v_mfma_f32_32x32x16_bf16 v[64:79], v[92:95], v[108:111], v[64:79]
    buffer_load_dwordx4 v231, s[24:27], s67 offen offset:1024 lds
    s_add_u32 s67, s67, 55296
    s_waitcnt lgkmcnt(2)
    v_mfma_f32_32x32x16_bf16 v[16:31], v[80:83], v[96:99], v[16:31]
    s_waitcnt vmcnt(4)
    ds_read_b64_tr_b16 v[88:89], v232 offset:6144
    ds_read_b64_tr_b16 v[90:91], v232 offset:6656
    v_mfma_f32_32x32x16_bf16 v[32:47], v[80:83], v[100:103], v[32:47]
    s_waitcnt lgkmcnt(2)
    ds_read_b128 v[104:107], v237 offset:19456
    ds_read_b128 v[108:111], v241 offset:19456
    s_add_u32 m0, s66, 4096
    v_mfma_f32_32x32x16_bf16 v[48:63], v[84:87], v[96:99], v[48:63]
    ds_read_b64_tr_b16 v[92:93], v233 offset:6144
    ds_read_b64_tr_b16 v[94:95], v233 offset:6656
    buffer_load_dwordx4 v230, s[24:27], s67 offen lds
    v_mfma_f32_32x32x16_bf16 v[64:79], v[84:87], v[100:103], v[64:79]
    buffer_load_dwordx4 v231, s[24:27], s67 offen offset:1024 lds
    s_add_u32 s67, s67, 55296
    s_waitcnt lgkmcnt(2)
    v_mfma_f32_32x32x16_bf16 v[16:31], v[88:91], v[104:107], v[16:31]
    s_waitcnt vmcnt(4)
    ds_read_b64_tr_b16 v[80:81], v232 offset:0
    ds_read_b64_tr_b16 v[82:83], v232 offset:512
    v_mfma_f32_32x32x16_bf16 v[32:47], v[88:91], v[108:111], v[32:47]
    s_waitcnt lgkmcnt(2)
    s_cmp_eq_u32 s69, 20
    s_cbranch_scc0 L_wrap_54
    v_subrev_u32 v234, 40960, v234
    v_subrev_u32 v238, 40960, v238
    v_subrev_u32 v235, 40960, v235
    v_subrev_u32 v239, 40960, v239
    v_subrev_u32 v236, 40960, v236
    v_subrev_u32 v240, 40960, v240
    v_subrev_u32 v237, 40960, v237
    v_subrev_u32 v241, 40960, v241
L_wrap_54:
    ds_read_b128 v[96:99], v234 offset:20480
    ds_read_b128 v[100:103], v238 offset:20480
    s_add_u32 m0, s66, 6144
    v_mfma_f32_32x32x16_bf16 v[48:63], v[92:95], v[104:107], v[48:63]
    ds_read_b64_tr_b16 v[84:85], v233 offset:0
    ds_read_b64_tr_b16 v[86:87], v233 offset:512
    buffer_load_dwordx4 v230, s[24:27], s67 offen lds
    v_mfma_f32_32x32x16_bf16 v[64:79], v[92:95], v[108:111], v[64:79]
    buffer_load_dwordx4 v231, s[24:27], s67 offen offset:1024 lds
    s_add_u32 s67, s67, 55296
    s_waitcnt lgkmcnt(2)
    v_mfma_f32_32x32x16_bf16 v[16:31], v[80:83], v[96:99], v[16:31]
    s_waitcnt vmcnt(4)
    ds_read_b64_tr_b16 v[88:89], v232 offset:2048
    ds_read_b64_tr_b16 v[90:91], v232 offset:2560
    v_mfma_f32_32x32x16_bf16 v[32:47], v[80:83], v[100:103], v[32:47]
    s_waitcnt lgkmcnt(2)
    ds_read_b128 v[104:107], v235 offset:21504
    ds_read_b128 v[108:111], v239 offset:21504
    s_add_u32 m0, s66, 0
    v_mfma_f32_32x32x16_bf16 v[48:63], v[84:87], v[96:99], v[48:63]
    ds_read_b64_tr_b16 v[92:93], v233 offset:2048
    ds_read_b64_tr_b16 v[94:95], v233 offset:2560
    buffer_load_dwordx4 v230, s[24:27], s67 offen lds
    v_mfma_f32_32x32x16_bf16 v[64:79], v[84:87], v[100:103], v[64:79]
    buffer_load_dwordx4 v231, s[24:27], s67 offen offset:1024 lds
    s_add_u32 s67, s67, 55296
    s_waitcnt lgkmcnt(2)
    v_mfma_f32_32x32x16_bf16 v[16:31], v[88:91], v[104:107], v[16:31]
    s_waitcnt vmcnt(4)
    ds_read_b64_tr_b16 v[80:81], v232 offset:4096
    ds_read_b64_tr_b16 v[82:83], v232 offset:4608
    v_mfma_f32_32x32x16_bf16 v[32:47], v[88:91], v[108:111], v[32:47]
    s_waitcnt lgkmcnt(2)
    ds_read_b128 v[96:99], v236 offset:22528
    ds_read_b128 v[100:103], v240 offset:22528
    s_add_u32 m0, s66, 2048
    v_mfma_f32_32x32x16_bf16 v[48:63], v[92:95], v[104:107], v[48:63]
    ds_read_b64_tr_b16 v[84:85], v233 offset:4096
    ds_read_b64_tr_b16 v[86:87], v233 offset:4608
    buffer_load_dwordx4 v230, s[24:27], s67 offen lds
    v_mfma_f32_32x32x16_bf16 v[64:79], v[92:95], v[108:111], v[64:79]
    buffer_load_dwordx4 v231, s[24:27], s67 offen offset:1024 lds
    s_add_u32 s67, s67, 55296
    s_waitcnt lgkmcnt(2)
    v_mfma_f32_32x32x16_bf16 v[16:31], v[80:83], v[96:99], v[16:31]
    s_waitcnt vmcnt(4)
    ds_read_b64_tr_b16 v[88:89], v232 offset:6144
    ds_read_b64_tr_b16 v[90:91], v232 offset:6656
    v_mfma_f32_32x32x16_bf16 v[32:47], v[80:83], v[100:103], v[32:47]
    s_waitcnt lgkmcnt(2)
    ds_read_b128 v[104:107], v237 offset:23552
    ds_read_b128 v[108:111], v241 offset:23552
    s_add_u32 m0, s66, 4096
    v_mfma_f32_32x32x16_bf16 v[48:63], v[84:87], v[96:99], v[48:63]
    ds_read_b64_tr_b16 v[92:93], v233 offset:6144
    ds_read_b64_tr_b16 v[94:95], v233 offset:6656
    buffer_load_dwordx4 v230, s[24:27], s67 offen lds
    v_mfma_f32_32x32x16_bf16 v[64:79], v[84:87], v[100:103], v[64:79]
    buffer_load_dwordx4 v231, s[24:27], s67 offen offset:1024 lds
    s_add_u32 s67, s67, 55296
    s_waitcnt lgkmcnt(2)
    v_mfma_f32_32x32x16_bf16 v[16:31], v[88:91], v[104:107], v[16:31]
    s_waitcnt vmcnt(4)
    ds_read_b64_tr_b16 v[80:81], v232 offset:0
    ds_read_b64_tr_b16 v[82:83], v232 offset:512
    v_mfma_f32_32x32x16_bf16 v[32:47], v[88:91], v[108:111], v[32:47]
    s_waitcnt lgkmcnt(2)
    ds_read_b128 v[96:99], v234 offset:24576
    ds_read_b128 v[100:103], v238 offset:24576
    s_add_u32 m0, s66, 6144
    v_mfma_f32_32x32x16_bf16 v[48:63], v[92:95], v[104:107], v[48:63]
    ds_read_b64_tr_b16 v[84:85], v233 offset:0
    ds_read_b64_tr_b16 v[86:87], v233 offset:512
    buffer_load_dwordx4 v230, s[24:27], s67 offen lds
    v_mfma_f32_32x32x16_bf16 v[64:79], v[92:95], v[108:111], v[64:79]
    buffer_load_dwordx4 v231, s[24:27], s67 offen offset:1024 lds
    s_add_u32 s67, s67, 55296
    s_cmp_eq_u32 s67, 2211840
    s_cselect_b32 s67, 0, s67
    s_waitcnt lgkmcnt(2)
    v_mfma_f32_32x32x16_bf16 v[16:31], v[80:83], v[96:99], v[16:31]
    s_waitcnt vmcnt(4)
    ds_read_b64_tr_b16 v[88:89], v232 offset:2048
    ds_read_b64_tr_b16 v[90:91], v232 offset:2560
    v_mfma_f32_32x32x16_bf16 v[32:47], v[80:83], v[100:103], v[32:47]
    s_waitcnt lgkmcnt(2)
    ds_read_b128 v[104:107], v235 offset:25600
    ds_read_b128 v[108:111], v239 offset:25600
    s_add_u32 m0, s66, 0
    v_mfma_f32_32x32x16_bf16 v[48:63], v[84:87], v[96:99], v[48:63]
    ds_read_b64_tr_b16 v[92:93], v233 offset:2048
    ds_read_b64_tr_b16 v[94:95], v233 offset:2560
    buffer_load_dwordx4 v230, s[24:27], s67 offen lds
    v_mfma_f32_32x32x16_bf16 v[64:79], v[84:87], v[100:103], v[64:79]
    buffer_load_dwordx4 v231, s[24:27], s67 offen offset:1024 lds
    s_add_u32 s67, s67, 55296
    s_waitcnt lgkmcnt(2)
    v_mfma_f32_32x32x16_bf16 v[16:31], v[88:91], v[104:107], v[16:31]
    s_waitcnt vmcnt(4)
    ds_read_b64_tr_b16 v[80:81], v232 offset:4096
    ds_read_b64_tr_b16 v[82:83], v232 offset:4608
    v_mfma_f32_32x32x16_bf16 v[32:47], v[88:91], v[108:111], v[32:47]
    s_waitcnt lgkmcnt(2)
    ds_read_b128 v[96:99], v236 offset:26624
    ds_read_b128 v[100:103], v240 offset:26624
    s_add_u32 m0, s66, 2048
    v_mfma_f32_32x32x16_bf16 v[48:63], v[92:95], v[104:107], v[48:63]
    ds_read_b64_tr_b16 v[84:85], v233 offset:4096
    ds_read_b64_tr_b16 v[86:87], v233 offset:4608
    buffer_load_dwordx4 v230, s[24:27], s67 offen lds
    v_mfma_f32_32x32x16_bf16 v[64:79], v[92:95], v[108:111], v[64:79]
    buffer_load_dwordx4 v231, s[24:27], s67 offen offset:1024 lds
    s_add_u32 s67, s67, 55296
    s_waitcnt lgkmcnt(2)
    v_mfma_f32_32x32x16_bf16 v[16:31], v[80:83], v[96:99], v[16:31]
    s_waitcnt vmcnt(4)
    ds_read_b64_tr_b16 v[88:89], v232 offset:6144
    ds_read_b64_tr_b16 v[90:91], v232 offset:6656
    v_mfma_f32_32x32x16_bf16 v[32:47], v[80:83], v[100:103], v[32:47]
    s_waitcnt lgkmcnt(2)
    ds_read_b128 v[104:107], v237 offset:27648
    ds_read_b128 v[108:111], v241 offset:27648
    s_add_u32 m0, s66, 4096
    v_mfma_f32_32x32x16_bf16 v[48:63], v[84:87], v[96:99], v[48:63]
    ds_read_b64_tr_b16 v[92:93], v233 offset:6144
    ds_read_b64_tr_b16 v[94:95], v233 offset:6656
    buffer_load_dwordx4 v230, s[24:27], s67 offen lds
    v_mfma_f32_32x32x16_bf16 v[64:79], v[84:87], v[100:103], v[64:79]
    buffer_load_dwordx4 v231, s[24:27], s67 offen offset:1024 lds
    s_add_u32 s67, s67, 55296
    s_waitcnt lgkmcnt(2)
    v_mfma_f32_32x32x16_bf16 v[16:31], v[88:91], v[104:107], v[16:31]
    s_waitcnt vmcnt(4)
    ds_read_b64_tr_b16 v[80:81], v232 offset:0
    ds_read_b64_tr_b16 v[82:83], v232 offset:512
    v_mfma_f32_32x32x16_bf16 v[32:47], v[88:91], v[108:111], v[32:47]
    s_waitcnt lgkmcnt(2)
    s_cmp_eq_u32 s69, 12
    s_cbranch_scc0 L_wrap_55
    v_subrev_u32 v234, 40960, v234
    v_subrev_u32 v238, 40960, v238
    v_subrev_u32 v235, 40960, v235
    v_subrev_u32 v239, 40960, v239
    v_subrev_u32 v236, 40960, v236
    v_subrev_u32 v240, 40960, v240
    v_subrev_u32 v237, 40960, v237
    v_subrev_u32 v241, 40960, v241
L_wrap_55:
    ds_read_b128 v[96:99], v234 offset:28672
    ds_read_b128 v[100:103], v238 offset:28672
    s_add_u32 m0, s66, 6144
    v_mfma_f32_32x32x16_bf16 v[48:63], v[92:95], v[104:107], v[48:63]
    ds_read_b64_tr_b16 v[84:85], v233 offset:0
    ds_read_b64_tr_b16 v[86:87], v233 offset:512
    buffer_load_dwordx4 v230, s[24:27], s67 offen lds
    v_mfma_f32_32x32x16_bf16 v[64:79], v[92:95], v[108:111], v[64:79]
    buffer_load_dwordx4 v231, s[24:27], s67 offen offset:1024 lds
    s_add_u32 s67, s67, 55296
    s_cmp_eq_u32 s67, 2211840
    s_cselect_b32 s67, 0, s67
    s_waitcnt lgkmcnt(2)
    v_mfma_f32_32x32x16_bf16 v[16:31], v[80:83], v[96:99], v[16:31]
    s_waitcnt vmcnt(4)
    ds_read_b64_tr_b16 v[88:89], v232 offset:2048
    ds_read_b64_tr_b16 v[90:91], v232 offset:2560
    v_mfma_f32_32x32x16_bf16 v[32:47], v[80:83], v[100:103], v[32:47]
    s_waitcnt lgkmcnt(2)
    ds_read_b128 v[104:107], v235 offset:29696
    ds_read_b128 v[108:111], v239 offset:29696
    s_add_u32 m0, s66, 0
    v_mfma_f32_32x32x16_bf16 v[48:63], v[84:87], v[96:99], v[48:63]
    ds_read_b64_tr_b16 v[92:93], v233 offset:2048
    ds_read_b64_tr_b16 v[94:95], v233 offset:2560
    buffer_load_dwordx4 v230, s[24:27], s67 offen lds
    v_mfma_f32_32x32x16_bf16 v[64:79], v[84:87], v[100:103], v[64:79]
    buffer_load_dwordx4 v231, s[24:27], s67 offen offset:1024 lds
    s_add_u32 s67, s67, 55296
    s_waitcnt lgkmcnt(2)
    v_mfma_f32_32x32x16_bf16 v[16:31], v[88:91], v[104:107], v[16:31]
    s_waitcnt vmcnt(4)
    ds_read_b64_tr_b16 v[80:81], v232 offset:4096
    ds_read_b64_tr_b16 v[82:83], v232 offset:4608
    v_mfma_f32_32x32x16_bf16 v[32:47], v[88:91], v[108:111], v[32:47]
    s_waitcnt lgkmcnt(2)
    ds_read_b128 v[96:99], v236 offset:30720
    ds_read_b128 v[100:103], v240 offset:30720
    s_add_u32 m0, s66, 2048
    v_mfma_f32_32x32x16_bf16 v[48:63], v[92:95], v[104:107], v[48:63]
    ds_read_b64_tr_b16 v[84:85], v233 offset:4096
    ds_read_b64_tr_b16 v[86:87], v233 offset:4608
    buffer_load_dwordx4 v230, s[24:27], s67 offen lds
    v_mfma_f32_32x32x16_bf16 v[64:79], v[92:95], v[108:111], v[64:79]
    buffer_load_dwordx4 v231, s[24:27], s67 offen offset:1024 lds
    s_add_u32 s67, s67, 55296
    s_waitcnt lgkmcnt(2)
    v_mfma_f32_32x32x16_bf16 v[16:31], v[80:83], v[96:99], v[16:31]
    s_waitcnt vmcnt(4)
    ds_read_b64_tr_b16 v[88:89], v232 offset:6144
    ds_read_b64_tr_b16 v[90:91], v232 offset:6656
    v_mfma_f32_32x32x16_bf16 v[32:47], v[80:83], v[100:103], v[32:47]
    s_waitcnt lgkmcnt(2)
    ds_read_b128 v[104:107], v237 offset:31744
    ds_read_b128 v[108:111], v241 offset:31744
    s_add_u32 m0, s66, 4096
    v_mfma_f32_32x32x16_bf16 v[48:63], v[84:87], v[96:99], v[48:63]
    ds_read_b64_tr_b16 v[92:93], v233 offset:6144
    ds_read_b64_tr_b16 v[94:95], v233 offset:6656
    buffer_load_dwordx4 v230, s[24:27], s67 offen lds
    v_mfma_f32_32x32x16_bf16 v[64:79], v[84:87], v[100:103], v[64:79]
    buffer_load_dwordx4 v231, s[24:27], s67 offen offset:1024 lds
    s_add_u32 s67, s67, 55296
    s_waitcnt lgkmcnt(2)
    v_mfma_f32_32x32x16_bf16 v[16:31], v[88:91], v[104:107], v[16:31]
    s_waitcnt vmcnt(4)
    ds_read_b64_tr_b16 v[80:81], v232 offset:0
    ds_read_b64_tr_b16 v[82:83], v232 offset:512
    v_mfma_f32_32x32x16_bf16 v[32:47], v[88:91], v[108:111], v[32:47]
    s_waitcnt lgkmcnt(2)
    s_cmp_eq_u32 s69, 8
    s_cbranch_scc0 L_wrap_56
    v_subrev_u32 v234, 40960, v234
    v_subrev_u32 v238, 40960, v238
    v_subrev_u32 v235, 40960, v235
    v_subrev_u32 v239, 40960, v239
    v_subrev_u32 v236, 40960, v236
    v_subrev_u32 v240, 40960, v240
    v_subrev_u32 v237, 40960, v237
    v_subrev_u32 v241, 40960, v241
L_wrap_56:
    ds_read_b128 v[96:99], v234 offset:32768
    ds_read_b128 v[100:103], v238 offset:32768
    s_add_u32 m0, s66, 6144
    v_mfma_f32_32x32x16_bf16 v[48:63], v[92:95], v[104:107], v[48:63]
    ds_read_b64_tr_b16 v[84:85], v233 offset:0
    ds_read_b64_tr_b16 v[86:87], v233 offset:512
    buffer_load_dwordx4 v230, s[24:27], s67 offen lds
    v_mfma_f32_32x32x16_bf16 v[64:79], v[92:95], v[108:111], v[64:79]
    buffer_load_dwordx4 v231, s[24:27], s67 offen offset:1024 lds
    s_add_u32 s67, s67, 55296
    s_cmp_eq_u32 s67, 2211840
    s_cselect_b32 s67, 0, s67
    s_waitcnt lgkmcnt(2)
    v_mfma_f32_32x32x16_bf16 v[16:31], v[80:83], v[96:99], v[16:31]
    s_waitcnt vmcnt(4)
    ds_read_b64_tr_b16 v[88:89], v232 offset:2048
    ds_read_b64_tr_b16 v[90:91], v232 offset:2560
    v_mfma_f32_32x32x16_bf16 v[32:47], v[80:83], v[100:103], v[32:47]
    s_waitcnt lgkmcnt(2)
    ds_read_b128 v[104:107], v235 offset:33792
    ds_read_b128 v[108:111], v239 offset:33792
    s_add_u32 m0, s66, 0
    v_mfma_f32_32x32x16_bf16 v[48:63], v[84:87], v[96:99], v[48:63]
    ds_read_b64_tr_b16 v[92:93], v233 offset:2048
    ds_read_b64_tr_b16 v[94:95], v233 offset:2560
    buffer_load_dwordx4 v230, s[24:27], s67 offen lds
    v_mfma_f32_32x32x16_bf16 v[64:79], v[84:87], v[100:103], v[64:79]
    buffer_load_dwordx4 v231, s[24:27], s67 offen offset:1024 lds
    s_add_u32 s67, s67, 55296
    s_waitcnt lgkmcnt(2)
    v_mfma_f32_32x32x16_bf16 v[16:31], v[88:91], v[104:107], v[16:31]
    s_waitcnt vmcnt(4)
    ds_read_b64_tr_b16 v[80:81], v232 offset:4096
    ds_read_b64_tr_b16 v[82:83], v232 offset:4608
    v_mfma_f32_32x32x16_bf16 v[32:47], v[88:91], v[108:111], v[32:47]
    s_waitcnt lgkmcnt(2)
    ds_read_b128 v[96:99], v236 offset:34816
    ds_read_b128 v[100:103], v240 offset:34816
    s_add_u32 m0, s66, 2048
    v_mfma_f32_32x32x16_bf16 v[48:63], v[92:95], v[104:107], v[48:63]
    ds_read_b64_tr_b16 v[84:85], v233 offset:4096
    ds_read_b64_tr_b16 v[86:87], v233 offset:4608
    buffer_load_dwordx4 v230, s[24:27], s67 offen lds
    v_mfma_f32_32x32x16_bf16 v[64:79], v[92:95], v[108:111], v[64:79]
    buffer_load_dwordx4 v231, s[24:27], s67 offen offset:1024 lds
    s_add_u32 s67, s67, 55296
    s_waitcnt lgkmcnt(2)
    v_mfma_f32_32x32x16_bf16 v[16:31], v[80:83], v[96:99], v[16:31]
    s_waitcnt vmcnt(4)
    ds_read_b64_tr_b16 v[88:89], v232 offset:6144
    ds_read_b64_tr_b16 v[90:91], v232 offset:6656
    v_mfma_f32_32x32x16_bf16 v[32:47], v[80:83], v[100:103], v[32:47]
    s_waitcnt lgkmcnt(2)
    ds_read_b128 v[104:107], v237 offset:35840
    ds_read_b128 v[108:111], v241 offset:35840
    s_add_u32 m0, s66, 4096
    v_mfma_f32_32x32x16_bf16 v[48:63], v[84:87], v[96:99], v[48:63]
    ds_read_b64_tr_b16 v[92:93], v233 offset:6144
    ds_read_b64_tr_b16 v[94:95], v233 offset:6656
    buffer_load_dwordx4 v230, s[24:27], s67 offen lds
    v_mfma_f32_32x32x16_bf16 v[64:79], v[84:87], v[100:103], v[64:79]
    buffer_load_dwordx4 v231, s[24:27], s67 offen offset:1024 lds
    s_add_u32 s67, s67, 55296
    s_waitcnt lgkmcnt(2)
    v_mfma_f32_32x32x16_bf16 v[16:31], v[88:91], v[104:107], v[16:31]
    s_waitcnt vmcnt(4)
    ds_read_b64_tr_b16 v[80:81], v232 offset:0
    ds_read_b64_tr_b16 v[82:83], v232 offset:512
    v_mfma_f32_32x32x16_bf16 v[32:47], v[88:91], v[108:111], v[32:47]
    s_waitcnt lgkmcnt(2)
    s_cmp_eq_u32 s69, 4
    s_cbranch_scc0 L_wrap_57
    v_subrev_u32 v234, 40960, v234
    v_subrev_u32 v238, 40960, v238
    v_subrev_u32 v235, 40960, v235
    v_subrev_u32 v239, 40960, v239
    v_subrev_u32 v236, 40960, v236
    v_subrev_u32 v240, 40960, v240
    v_subrev_u32 v237, 40960, v237
    v_subrev_u32 v241, 40960, v241
L_wrap_57:
    ds_read_b128 v[96:99], v234 offset:36864
    ds_read_b128 v[100:103], v238 offset:36864
    s_add_u32 m0, s66, 6144
    v_mfma_f32_32x32x16_bf16 v[48:63], v[92:95], v[104:107], v[48:63]
    ds_read_b64_tr_b16 v[84:85], v233 offset:0
    ds_read_b64_tr_b16 v[86:87], v233 offset:512
    buffer_load_dwordx4 v230, s[24:27], s67 offen lds
    v_mfma_f32_32x32x16_bf16 v[64:79], v[92:95], v[108:111], v[64:79]
    buffer_load_dwordx4 v231, s[24:27], s67 offen offset:1024 lds
    s_add_u32 s67, s67, 55296
    s_waitcnt lgkmcnt(2)
    v_mfma_f32_32x32x16_bf16 v[16:31], v[80:83], v[96:99], v[16:31]
    s_waitcnt vmcnt(4)
    ds_read_b64_tr_b16 v[88:89], v232 offset:2048
    ds_read_b64_tr_b16 v[90:91], v232 offset:2560
    v_mfma_f32_32x32x16_bf16 v[32:47], v[80:83], v[100:103], v[32:47]
    s_waitcnt lgkmcnt(2)
    ds_read_b128 v[104:107], v235 offset:37888
    ds_read_b128 v[108:111], v239 offset:37888
    v_mfma_f32_32x32x16_bf16 v[48:63], v[84:87], v[96:99], v[48:63]
    ds_read_b64_tr_b16 v[92:93], v233 offset:2048
    ds_read_b64_tr_b16 v[94:95], v233 offset:2560
    v_mfma_f32_32x32x16_bf16 v[64:79], v[84:87], v[100:103], v[64:79]
    s_waitcnt lgkmcnt(2)
    v_mfma_f32_32x32x16_bf16 v[16:31], v[88:91], v[104:107], v[16:31]
    s_waitcnt vmcnt(2)
    ds_read_b64_tr_b16 v[80:81], v232 offset:4096
    ds_read_b64_tr_b16 v[82:83], v232 offset:4608
    v_mfma_f32_32x32x16_bf16 v[32:47], v[88:91], v[108:111], v[32:47]
    s_waitcnt lgkmcnt(2)
    ds_read_b128 v[96:99], v236 offset:38912
    ds_read_b128 v[100:103], v240 offset:38912
    v_mfma_f32_32x32x16_bf16 v[48:63], v[92:95], v[104:107], v[48:63]
    ds_read_b64_tr_b16 v[84:85], v233 offset:4096
    ds_read_b64_tr_b16 v[86:87], v233 offset:4608
    v_mfma_f32_32x32x16_bf16 v[64:79], v[92:95], v[108:111], v[64:79]
    s_waitcnt lgkmcnt(2)
    v_mfma_f32_32x32x16_bf16 v[16:31], v[80:83], v[96:99], v[16:31]
    s_waitcnt vmcnt(0)
    ds_read_b64_tr_b16 v[88:89], v232 offset:6144
    ds_read_b64_tr_b16 v[90:91], v232 offset:6656
    v_mfma_f32_32x32x16_bf16 v[32:47], v[80:83], v[100:103], v[32:47]
    s_waitcnt lgkmcnt(2)
    ds_read_b128 v[104:107], v237 offset:39936
    ds_read_b128 v[108:111], v241 offset:39936
    v_mfma_f32_32x32x16_bf16 v[48:63], v[84:87], v[96:99], v[48:63]
    ds_read_b64_tr_b16 v[92:93], v233 offset:6144
    ds_read_b64_tr_b16 v[94:95], v233 offset:6656
    v_mfma_f32_32x32x16_bf16 v[64:79], v[84:87], v[100:103], v[64:79]
    s_waitcnt lgkmcnt(2)
    v_mfma_f32_32x32x16_bf16 v[16:31], v[88:91], v[104:107], v[16:31]
    v_mfma_f32_32x32x16_bf16 v[32:47], v[88:91], v[108:111], v[32:47]
    s_waitcnt lgkmcnt(0)
    v_mfma_f32_32x32x16_bf16 v[48:63], v[92:95], v[104:107], v[48:63]
    v_mfma_f32_32x32x16_bf16 v[64:79], v[92:95], v[108:111], v[64:79]
    ds_add_u32 v242, v244 offset:20
    s_setprio 3
    s_lshl_b32 s62, s4, 1
    s_mul_i32 s62, s62, 110592
    s_lshl_b32 s63, s68, 11
    s_add_u32 s62, s62, s63
    s_add_u32 s62, s62, 1048576
    s_nop 5
    v_cvt_pk_bf16_f32 v80, v16, v17
    v_cvt_pk_bf16_f32 v81, v18, v19
    v_cvt_pk_bf16_f32 v82, v20, v21
    v_cvt_pk_bf16_f32 v83, v22, v23
    v_cvt_pk_bf16_f32 v84, v24, v25
    v_cvt_pk_bf16_f32 v85, v26, v27
    v_cvt_pk_bf16_f32 v86, v28, v29
    v_cvt_pk_bf16_f32 v87, v30, v31
    v_pk_max_i16 v80, v80, 0
    v_pk_max_i16 v81, v81, 0
    v_pk_max_i16 v82, v82, 0
    v_pk_max_i16 v83, v83, 0
    v_pk_max_i16 v84, v84, 0
    v_pk_max_i16 v85, v85, 0
    v_pk_max_i16 v86, v86, 0
    v_pk_max_i16 v87, v87, 0
    s_add_u32 s63, s62, 0
    buffer_store_dwordx4 v[80:83], v245, s[36:39], s63 offen sc1
    buffer_store_dwordx4 v[84:87], v245, s[36:39], s63 offen offset:1024 sc1
    v_cvt_pk_bf16_f32 v88, v32, v33
    v_cvt_pk_bf16_f32 v89, v34, v35
    v_cvt_pk_bf16_f32 v90, v36, v37
    v_cvt_pk_bf16_f32 v91, v38, v39
    v_cvt_pk_bf16_f32 v92, v40, v41
    v_cvt_pk_bf16_f32 v93, v42, v43
    v_cvt_pk_bf16_f32 v94, v44, v45
    v_cvt_pk_bf16_f32 v95, v46, v47
    v_pk_max_i16 v88, v88, 0
    v_pk_max_i16 v89, v89, 0
    v_pk_max_i16 v90, v90, 0
    v_pk_max_i16 v91, v91, 0
    v_pk_max_i16 v92, v92, 0
    v_pk_max_i16 v93, v93, 0
    v_pk_max_i16 v94, v94, 0
    v_pk_max_i16 v95, v95, 0
    s_add_u32 s63, s62, 110592
    buffer_store_dwordx4 v[88:91], v245, s[36:39], s63 offen sc1
    buffer_store_dwordx4 v[92:95], v245, s[36:39], s63 offen offset:1024 sc1
    v_cvt_pk_bf16_f32 v96, v48, v49
    v_cvt_pk_bf16_f32 v97, v50, v51
    v_cvt_pk_bf16_f32 v98, v52, v53
    v_cvt_pk_bf16_f32 v99, v54, v55
    v_cvt_pk_bf16_f32 v100, v56, v57
    v_cvt_pk_bf16_f32 v101, v58, v59
    v_cvt_pk_bf16_f32 v102, v60, v61
    v_cvt_pk_bf16_f32 v103, v62, v63
    v_pk_max_i16 v96, v96, 0
    v_pk_max_i16 v97, v97, 0
    v_pk_max_i16 v98, v98, 0
    v_pk_max_i16 v99, v99, 0
    v_pk_max_i16 v100, v100, 0
    v_pk_max_i16 v101, v101, 0
    v_pk_max_i16 v102, v102, 0
    v_pk_max_i16 v103, v103, 0
    s_add_u32 s63, s62, 2048
    buffer_store_dwordx4 v[96:99], v245, s[36:39], s63 offen sc1
    buffer_store_dwordx4 v[100:103], v245, s[36:39], s63 offen offset:1024 sc1
    v_cvt_pk_bf16_f32 v104, v64, v65
    v_cvt_pk_bf16_f32 v105, v66, v67
    v_cvt_pk_bf16_f32 v106, v68, v69
    v_cvt_pk_bf16_f32 v107, v70, v71
    v_cvt_pk_bf16_f32 v108, v72, v73
    v_cvt_pk_bf16_f32 v109, v74, v75
    v_cvt_pk_bf16_f32 v110, v76, v77
    v_cvt_pk_bf16_f32 v111, v78, v79
    v_pk_max_i16 v104, v104, 0
    v_pk_max_i16 v105, v105, 0
    v_pk_max_i16 v106, v106, 0
    v_pk_max_i16 v107, v107, 0
    v_pk_max_i16 v108, v108, 0
    v_pk_max_i16 v109, v109, 0
    v_pk_max_i16 v110, v110, 0
    v_pk_max_i16 v111, v111, 0
    s_add_u32 s63, s62, 112640
    buffer_store_dwordx4 v[104:107], v245, s[36:39], s63 offen sc1
    buffer_store_dwordx4 v[108:111], v245, s[36:39], s63 offen offset:1024 sc1
    s_setprio 0
    s_branch L_hdone_50
L_nopair_49:
    s_setprio 0
    ds_add_u32 v242, v244 offset:20
L_hdone_50:
    s_waitcnt vmcnt(0)
    ds_add_rtn_u32 v246, v242, v244 offset:24
    s_waitcnt lgkmcnt(0)
    v_readfirstlane_b32 s62, v246
    s_nop 0
    s_cmp_lg_u32 s62, 3
    s_cbranch_scc1 L_hnf_58
    s_lshl_b32 s62, s4, 7
    s_lshl_b32 s63, s5, 2
    s_add_u32 s62, s62, s63
    s_add_u32 s62, s62, 16384
    v_mov_b32 v247, s6
    v_mov_b32 v246, 0
    s_mov_b64 exec, 1
    buffer_store_dword v247, v246, s[36:39], s62 offen sc1
    s_mov_b64 exec, -1
L_hnf_58:
    s_mov_b32 s62, 0
L_spin_59:
    ds_read_b32 v246, v243 offset:20
    s_waitcnt lgkmcnt(0)
    v_cmp_gt_u32 vcc, 8, v246
    s_cbranch_vccz L_spind_60
    s_add_u32 s62, s62, 1
    s_cmp_lt_u32 s62, 400000
    s_sleep 1
    s_cbranch_scc1 L_spin_59
L_spind_60:
    s_mul_i32 s84, s7, 552960
    s_and_b32 s62, s4, 7
    s_mul_i32 s62, s62, 3
    s_and_b32 s63, s5, 3
    s_mul_i32 s63, s63, 7
    s_add_u32 s62, s62, s63
    s_cmp_ge_u32 s62, 27
    s_cselect_b32 s63, 27, 0
    s_sub_u32 s87, s62, s63
    s_mul_i32 s95, s87, 20480
    s_add_u32 s95, s95, s84
    s_add_u32 s93, s84, 552960
    s_add_u32 m0, s83, 0
    s_nop 0
    buffer_load_dwordx4 v220, s[28:31], s95 offen lds
    buffer_load_dwordx4 v221, s[28:31], s95 offen offset:1024 lds
    s_add_u32 m0, s83, 2048
    s_nop 0
    buffer_load_dwordx4 v222, s[28:31], s95 offen lds
    s_add_u32 s95, s95, 20480
    s_cmp_eq_u32 s95, s93
    s_cselect_b32 s95, s84, s95
    s_add_u32 m0, s83, 3072
    s_nop 0
    buffer_load_dwordx4 v220, s[28:31], s95 offen lds
    buffer_load_dwordx4 v221, s[28:31], s95 offen offset:1024 lds
    s_add_u32 m0, s83, 5120
    s_nop 0
    buffer_load_dwordx4 v222, s[28:31], s95 offen lds
    s_add_u32 s95, s95, 20480
    s_cmp_eq_u32 s95, s93
    s_cselect_b32 s95, s84, s95
    s_add_u32 m0, s83, 6144
    s_nop 0
    buffer_load_dwordx4 v220, s[28:31], s95 offen lds
    buffer_load_dwordx4 v221, s[28:31], s95 offen offset:1024 lds
    s_add_u32 m0, s83, 8192
    s_nop 0
    buffer_load_dwordx4 v222, s[28:31], s95 offen lds
    s_add_u32 s95, s95, 20480
    s_cmp_eq_u32 s95, s93
    s_cselect_b32 s95, s84, s95
    s_add_u32 m0, s83, 9216
    s_nop 0
    buffer_load_dwordx4 v220, s[28:31], s95 offen lds
    buffer_load_dwordx4 v221, s[28:31], s95 offen offset:1024 lds
    s_add_u32 m0, s83, 11264
    s_nop 0
    buffer_load_dwordx4 v222, s[28:31], s95 offen lds
    s_add_u32 s95, s95, 20480
    s_cmp_eq_u32 s95, s93
    s_cselect_b32 s95, s84, s95
    s_cmp_lg_u32 s7, 0
    s_cbranch_scc1 L_opw_61
    v_and_b32 v246, 7, v0
    v_lshlrev_b32 v246, 2, v246
    s_lshl_b32 s63, s4, 7
    s_add_u32 s63, s63, 16384
    s_mov_b32 s62, 0
L_poll_63:
    buffer_load_dword v247, v246, s[36:39], s63 offen sc1
    s_waitcnt vmcnt(0)
    v_cmp_ne_u32 vcc, s6, v247
    s_cbranch_vccz L_polld_64
    s_add_u32 s62, s62, 1
    s_cmp_lt_u32 s62, 40000
    s_sleep 8
    s_cbranch_scc1 L_poll_63
L_polld_64:
    ds_add_u32 v242, v244 offset:40
    s_branch L_opj_62
L_opw_61:
    s_mov_b32 s62, 0
L_spin_65:
    ds_read_b32 v246, v243 offset:40
    s_waitcnt lgkmcnt(0)
    v_cmp_gt_u32 vcc, 1, v246
    s_cbranch_vccz L_spind_66
    s_add_u32 s62, s62, 1
    s_cmp_lt_u32 s62, 400000
    s_sleep 2
    s_cbranch_scc1 L_spin_65
L_spind_66:
L_opj_62:
    s_waitcnt lgkmcnt(0)
    s_lshl_b32 s62, s5, 2
    s_add_u32 s62, s62, s7
    s_cmp_lg_u32 s62, 0
    s_cbranch_scc1 L_nolead_67
    v_mov_b32 v246, 0
    v_mov_b32 v247, 1
    s_mov_b64 exec, 1
    global_atomic_add v248, v246, v247, s[58:59] sc0 sc1
    s_waitcnt vmcnt(0)
    v_readfirstlane_b32 s62, v248
    s_mov_b64 exec, -1
    s_nop 0
    s_cmp_lg_u32 s62, 31
    s_cbranch_scc1 L_nolead_67
    v_mov_b32 v247, s6
    v_mov_b32 v246, 0
    s_mov_b32 s62, 0
    s_mov_b64 exec, 1
    buffer_store_dword v247, v246, s[36:39], s62 offen sc1
    s_mov_b64 exec, -1
L_nolead_67:
    s_lshl_b32 s96, s87, 10
    buffer_load_dwordx4 v[120:123], v15, s[36:39], s96 offen sc1
    buffer_load_dwordx4 v[124:127], v250, s[36:39], s96 offen sc1
    s_add_u32 s96, s96, 1024
    s_cmp_eq_u32 s96, 27648
    s_cselect_b32 s96, 0, s96
    buffer_load_dwordx4 v[128:131], v15, s[36:39], s96 offen sc1
    buffer_load_dwordx4 v[132:135], v250, s[36:39], s96 offen sc1
    s_add_u32 s96, s96, 1024
    s_cmp_eq_u32 s96, 27648
    s_cselect_b32 s96, 0, s96
    buffer_load_dwordx4 v[136:139], v15, s[36:39], s96 offen sc1
    buffer_load_dwordx4 v[140:143], v250, s[36:39], s96 offen sc1
    s_add_u32 s96, s96, 1024
    s_cmp_eq_u32 s96, 27648
    s_cselect_b32 s96, 0, s96
    s_waitcnt vmcnt(15)
    ds_read_b64_tr_b16 v[96:97], v8 offset:0
    ds_read_b64_tr_b16 v[98:99], v8 offset:1024
    ds_read_b64_tr_b16 v[100:101], v9 offset:0
    ds_read_b64_tr_b16 v[102:103], v9 offset:1024
    ds_read_b64_tr_b16 v[104:105], v10 offset:0
    ds_read_b64_tr_b16 v[106:107], v10 offset:512
    s_waitcnt vmcnt(4) lgkmcnt(0)
    v_mfma_f32_32x32x16_bf16 v[16:31], v[96:99], v[120:123], 0
    ds_read_b64_tr_b16 v[108:109], v8 offset:3072
    ds_read_b64_tr_b16 v[110:111], v8 offset:4096
    buffer_load_dwordx4 v[144:147], v15, s[36:39], s96 offen sc1
    v_mfma_f32_32x32x16_bf16 v[32:47], v[96:99], v[124:127], 0
    ds_read_b64_tr_b16 v[112:113], v9 offset:3072
    ds_read_b64_tr_b16 v[114:115], v9 offset:4096
    buffer_load_dwordx4 v[148:151], v250, s[36:39], s96 offen sc1
    s_add_u32 s96, s96, 1024
    s_cmp_eq_u32 s96, 27648
    s_cselect_b32 s96, 0, s96
    s_add_u32 m0, s83, 12288
    v_mfma_f32_32x32x16_bf16 v[48:63], v[100:103], v[120:123], 0
    ds_read_b64_tr_b16 v[116:117], v10 offset:3072
    ds_read_b64_tr_b16 v[118:119], v10 offset:3584
    buffer_load_dwordx4 v220, s[28:31], s95 offen lds
    v_mfma_f32_32x32x16_bf16 v[64:79], v[100:103], v[124:127], 0
    buffer_load_dwordx4 v221, s[28:31], s95 offen offset:1024 lds
    s_add_u32 m0, s83, 14336
    v_mfma_f32_32x32x16_bf16 v[80:95], v[104:107], v[120:123], 0
    buffer_load_dwordx4 v222, s[28:31], s95 offen lds
    s_add_u32 s95, s95, 20480
    s_cmp_eq_u32 s95, s93
    s_cselect_b32 s95, s84, s95
    s_waitcnt vmcnt(7) lgkmcnt(0)
    v_mfma_f32_32x32x16_bf16 v[16:31], v[108:111], v[128:131], v[16:31]
    ds_read_b64_tr_b16 v[96:97], v8 offset:6144
    ds_read_b64_tr_b16 v[98:99], v8 offset:7168
    buffer_load_dwordx4 v[120:123], v15, s[36:39], s96 offen sc1
    v_mfma_f32_32x32x16_bf16 v[32:47], v[108:111], v[132:135], v[32:47]
    ds_read_b64_tr_b16 v[100:101], v9 offset:6144
    ds_read_b64_tr_b16 v[102:103], v9 offset:7168
    buffer_load_dwordx4 v[124:127], v250, s[36:39], s96 offen sc1
    s_add_u32 s96, s96, 1024
    s_cmp_eq_u32 s96, 27648
    s_cselect_b32 s96, 0, s96
    s_add_u32 m0, s83, 15360
    v_mfma_f32_32x32x16_bf16 v[48:63], v[112:115], v[128:131], v[48:63]
    ds_read_b64_tr_b16 v[104:105], v10 offset:6144
    ds_read_b64_tr_b16 v[106:107], v10 offset:6656
    buffer_load_dwordx4 v220, s[28:31], s95 offen lds
    v_mfma_f32_32x32x16_bf16 v[64:79], v[112:115], v[132:135], v[64:79]
    buffer_load_dwordx4 v221, s[28:31], s95 offen offset:1024 lds
    s_add_u32 m0, s83, 17408
    v_mfma_f32_32x32x16_bf16 v[80:95], v[116:119], v[128:131], v[80:95]
    buffer_load_dwordx4 v222, s[28:31], s95 offen lds
    s_add_u32 s95, s95, 20480
    s_cmp_eq_u32 s95, s93
    s_cselect_b32 s95, s84, s95
    s_waitcnt vmcnt(10) lgkmcnt(0)
    v_mfma_f32_32x32x16_bf16 v[16:31], v[96:99], v[136:139], v[16:31]
    ds_read_b64_tr_b16 v[108:109], v8 offset:9216
    ds_read_b64_tr_b16 v[110:111], v8 offset:10240
    buffer_load_dwordx4 v[128:131], v15, s[36:39], s96 offen sc1
    v_mfma_f32_32x32x16_bf16 v[32:47], v[96:99], v[140:143], v[32:47]
    ds_read_b64_tr_b16 v[112:113], v9 offset:9216
    ds_read_b64_tr_b16 v[114:115], v9 offset:10240
    buffer_load_dwordx4 v[132:135], v250, s[36:39], s96 offen sc1
    s_add_u32 s96, s96, 1024
    s_cmp_eq_u32 s96, 27648
    s_cselect_b32 s96, 0, s96
    s_add_u32 m0, s83, 18432
    v_mfma_f32_32x32x16_bf16 v[48:63], v[100:103], v[136:139], v[48:63]
    ds_read_b64_tr_b16 v[116:117], v10 offset:9216
    ds_read_b64_tr_b16 v[118:119], v10 offset:9728
    buffer_load_dwordx4 v220, s[28:31], s95 offen lds
    v_mfma_f32_32x32x16_bf16 v[64:79], v[100:103], v[140:143], v[64:79]
    buffer_load_dwordx4 v221, s[28:31], s95 offen offset:1024 lds
    s_add_u32 m0, s83, 20480
    v_mfma_f32_32x32x16_bf16 v[80:95], v[104:107], v[136:139], v[80:95]
    buffer_load_dwordx4 v222, s[28:31], s95 offen lds
    s_add_u32 s95, s95, 20480
    s_cmp_eq_u32 s95, s93
    s_cselect_b32 s95, s84, s95
    s_waitcnt vmcnt(13) lgkmcnt(0)
    v_mfma_f32_32x32x16_bf16 v[16:31], v[108:111], v[144:147], v[16:31]
    s_waitcnt vmcnt(10)
    ds_read_b64_tr_b16 v[96:97], v8 offset:12288
    ds_read_b64_tr_b16 v[98:99], v8 offset:13312
    buffer_load_dwordx4 v[136:139], v15, s[36:39], s96 offen sc1
    v_mfma_f32_32x32x16_bf16 v[32:47], v[108:111], v[148:151], v[32:47]
    ds_read_b64_tr_b16 v[100:101], v9 offset:12288
    ds_read_b64_tr_b16 v[102:103], v9 offset:13312
    buffer_load_dwordx4 v[140:143], v250, s[36:39], s96 offen sc1
    s_add_u32 s96, s96, 1024
    s_cmp_eq_u32 s96, 27648
    s_cselect_b32 s96, 0, s96
    s_add_u32 m0, s83, 21504
    v_mfma_f32_32x32x16_bf16 v[48:63], v[112:115], v[144:147], v[48:63]
    ds_read_b64_tr_b16 v[104:105], v10 offset:12288
    ds_read_b64_tr_b16 v[106:107], v10 offset:12800
    buffer_load_dwordx4 v220, s[28:31], s95 offen lds
    v_mfma_f32_32x32x16_bf16 v[64:79], v[112:115], v[148:151], v[64:79]
    buffer_load_dwordx4 v221, s[28:31], s95 offen offset:1024 lds
    s_add_u32 m0, s83, 23552
    v_mfma_f32_32x32x16_bf16 v[80:95], v[116:119], v[144:147], v[80:95]
    buffer_load_dwordx4 v222, s[28:31], s95 offen lds
    s_add_u32 s95, s95, 20480
    s_cmp_eq_u32 s95, s93
    s_cselect_b32 s95, s84, s95
    s_waitcnt vmcnt(13) lgkmcnt(0)
    v_mfma_f32_32x32x16_bf16 v[16:31], v[96:99], v[120:123], v[16:31]
    s_waitcnt vmcnt(10)
    ds_read_b64_tr_b16 v[108:109], v8 offset:15360
    ds_read_b64_tr_b16 v[110:111], v8 offset:16384
    buffer_load_dwordx4 v[144:147], v15, s[36:39], s96 offen sc1
    v_mfma_f32_32x32x16_bf16 v[32:47], v[96:99], v[124:127], v[32:47]
    ds_read_b64_tr_b16 v[112:113], v9 offset:15360
    ds_read_b64_tr_b16 v[114:115], v9 offset:16384
    buffer_load_dwordx4 v[148:151], v250, s[36:39], s96 offen sc1
    s_add_u32 s96, s96, 1024
    s_cmp_eq_u32 s96, 27648
    s_cselect_b32 s96, 0, s96
    s_add_u32 m0, s83, 24576
    v_mfma_f32_32x32x16_bf16 v[48:63], v[100:103], v[120:123], v[48:63]
    ds_read_b64_tr_b16 v[116:117], v10 offset:15360
    ds_read_b64_tr_b16 v[118:119], v10 offset:15872
    buffer_load_dwordx4 v220, s[28:31], s95 offen lds
    v_mfma_f32_32x32x16_bf16 v[64:79], v[100:103], v[124:127], v[64:79]
    buffer_load_dwordx4 v221, s[28:31], s95 offen offset:1024 lds
    s_add_u32 m0, s83, 26624
    v_mfma_f32_32x32x16_bf16 v[80:95], v[104:107], v[120:123], v[80:95]
    buffer_load_dwordx4 v222, s[28:31], s95 offen lds
    s_add_u32 s95, s95, 20480
    s_cmp_eq_u32 s95, s93
    s_cselect_b32 s95, s84, s95
    s_waitcnt vmcnt(13) lgkmcnt(0)
    v_mfma_f32_32x32x16_bf16 v[16:31], v[108:111], v[128:131], v[16:31]
    s_waitcnt vmcnt(10)
    ds_read_b64_tr_b16 v[96:97], v8 offset:18432
    ds_read_b64_tr_b16 v[98:99], v8 offset:19456
    buffer_load_dwordx4 v[120:123], v15, s[36:39], s96 offen sc1
    v_mfma_f32_32x32x16_bf16 v[32:47], v[108:111], v[132:135], v[32:47]
    ds_read_b64_tr_b16 v[100:101], v9 offset:18432
    ds_read_b64_tr_b16 v[102:103], v9 offset:19456
    buffer_load_dwordx4 v[124:127], v250, s[36:39], s96 offen sc1
    s_add_u32 s96, s96, 1024
    s_cmp_eq_u32 s96, 27648
    s_cselect_b32 s96, 0, s96
    s_add_u32 m0, s83, 0
    v_mfma_f32_32x32x16_bf16 v[48:63], v[112:115], v[128:131], v[48:63]
    ds_read_b64_tr_b16 v[104:105], v10 offset:18432
    ds_read_b64_tr_b16 v[106:107], v10 offset:18944
    buffer_load_dwordx4 v220, s[28:31], s95 offen lds
    v_mfma_f32_32x32x16_bf16 v[64:79], v[112:115], v[132:135], v[64:79]
    buffer_load_dwordx4 v221, s[28:31], s95 offen offset:1024 lds
    s_add_u32 m0, s83, 2048
    v_mfma_f32_32x32x16_bf16 v[80:95], v[116:119], v[128:131], v[80:95]
    buffer_load_dwordx4 v222, s[28:31], s95 offen lds
    s_add_u32 s95, s95, 20480
    s_cmp_eq_u32 s95, s93
    s_cselect_b32 s95, s84, s95
    s_waitcnt vmcnt(13) lgkmcnt(0)
    v_mfma_f32_32x32x16_bf16 v[16:31], v[96:99], v[136:139], v[16:31]
    s_waitcnt vmcnt(10)
    ds_read_b64_tr_b16 v[108:109], v8 offset:21504
    ds_read_b64_tr_b16 v[110:111], v8 offset:22528
    buffer_load_dwordx4 v[128:131], v15, s[36:39], s96 offen sc1
    v_mfma_f32_32x32x16_bf16 v[32:47], v[96:99], v[140:143], v[32:47]
    ds_read_b64_tr_b16 v[112:113], v9 offset:21504
    ds_read_b64_tr_b16 v[114:115], v9 offset:22528
    buffer_load_dwordx4 v[132:135], v250, s[36:39], s96 offen sc1
    s_add_u32 s96, s96, 1024
    s_cmp_eq_u32 s96, 27648
    s_cselect_b32 s96, 0, s96
    s_add_u32 m0, s83, 3072
    v_mfma_f32_32x32x16_bf16 v[48:63], v[100:103], v[136:139], v[48:63]
    ds_read_b64_tr_b16 v[116:117], v10 offset:21504
    ds_read_b64_tr_b16 v[118:119], v10 offset:22016
    buffer_load_dwordx4 v220, s[28:31], s95 offen lds
    v_mfma_f32_32x32x16_bf16 v[64:79], v[100:103], v[140:143], v[64:79]
    buffer_load_dwordx4 v221, s[28:31], s95 offen offset:1024 lds
    s_add_u32 m0, s83, 5120
    v_mfma_f32_32x32x16_bf16 v[80:95], v[104:107], v[136:139], v[80:95]
    buffer_load_dwordx4 v222, s[28:31], s95 offen lds
    s_add_u32 s95, s95, 20480
    s_cmp_eq_u32 s95, s93
    s_cselect_b32 s95, s84, s95
    s_waitcnt vmcnt(13) lgkmcnt(0)
    v_mfma_f32_32x32x16_bf16 v[16:31], v[108:111], v[144:147], v[16:31]
    s_waitcnt vmcnt(10)
    ds_read_b64_tr_b16 v[96:97], v8 offset:24576
    ds_read_b64_tr_b16 v[98:99], v8 offset:25600
    buffer_load_dwordx4 v[136:139], v15, s[36:39], s96 offen sc1
    v_mfma_f32_32x32x16_bf16 v[32:47], v[108:111], v[148:151], v[32:47]
    ds_read_b64_tr_b16 v[100:101], v9 offset:24576
    ds_read_b64_tr_b16 v[102:103], v9 offset:25600
    buffer_load_dwordx4 v[140:143], v250, s[36:39], s96 offen sc1
    s_add_u32 s96, s96, 1024
    s_cmp_eq_u32 s96, 27648
    s_cselect_b32 s96, 0, s96
    s_add_u32 m0, s83, 6144
    v_mfma_f32_32x32x16_bf16 v[48:63], v[112:115], v[144:147], v[48:63]
    ds_read_b64_tr_b16 v[104:105], v10 offset:24576
    ds_read_b64_tr_b16 v[106:107], v10 offset:25088
    buffer_load_dwordx4 v220, s[28:31], s95 offen lds
    v_mfma_f32_32x32x16_bf16 v[64:79], v[112:115], v[148:151], v[64:79]
    buffer_load_dwordx4 v221, s[28:31], s95 offen offset:1024 lds
    s_add_u32 m0, s83, 8192
    v_mfma_f32_32x32x16_bf16 v[80:95], v[116:119], v[144:147], v[80:95]
    buffer_load_dwordx4 v222, s[28:31], s95 offen lds
    s_add_u32 s95, s95, 20480
    s_cmp_eq_u32 s95, s93
    s_cselect_b32 s95, s84, s95
    s_waitcnt vmcnt(13) lgkmcnt(0)
    v_mfma_f32_32x32x16_bf16 v[16:31], v[96:99], v[120:123], v[16:31]
    s_waitcnt vmcnt(10)
    ds_read_b64_tr_b16 v[108:109], v8 offset:0
    ds_read_b64_tr_b16 v[110:111], v8 offset:1024
    buffer_load_dwordx4 v[144:147], v15, s[36:39], s96 offen sc1
    v_mfma_f32_32x32x16_bf16 v[32:47], v[96:99], v[124:127], v[32:47]
    ds_read_b64_tr_b16 v[112:113], v9 offset:0
    ds_read_b64_tr_b16 v[114:115], v9 offset:1024
    buffer_load_dwordx4 v[148:151], v250, s[36:39], s96 offen sc1
    s_add_u32 s96, s96, 1024
    s_cmp_eq_u32 s96, 27648
    s_cselect_b32 s96, 0, s96
    s_add_u32 m0, s83, 9216
    v_mfma_f32_32x32x16_bf16 v[48:63], v[100:103], v[120:123], v[48:63]
    ds_read_b64_tr_b16 v[116:117], v10 offset:0
    ds_read_b64_tr_b16 v[118:119], v10 offset:512
    buffer_load_dwordx4 v220, s[28:31], s95 offen lds
    v_mfma_f32_32x32x16_bf16 v[64:79], v[100:103], v[124:127], v[64:79]
    buffer_load_dwordx4 v221, s[28:31], s95 offen offset:1024 lds
    s_add_u32 m0, s83, 11264
    v_mfma_f32_32x32x16_bf16 v[80:95], v[104:107], v[120:123], v[80:95]
    buffer_load_dwordx4 v222, s[28:31], s95 offen lds
    s_add_u32 s95, s95, 20480
    s_cmp_eq_u32 s95, s93
    s_cselect_b32 s95, s84, s95
    s_waitcnt vmcnt(13) lgkmcnt(0)
    v_mfma_f32_32x32x16_bf16 v[16:31], v[108:111], v[128:131], v[16:31]
    s_waitcnt vmcnt(10)
    ds_read_b64_tr_b16 v[96:97], v8 offset:3072
    ds_read_b64_tr_b16 v[98:99], v8 offset:4096
    buffer_load_dwordx4 v[120:123], v15, s[36:39], s96 offen sc1
    v_mfma_f32_32x32x16_bf16 v[32:47], v[108:111], v[132:135], v[32:47]
    ds_read_b64_tr_b16 v[100:101], v9 offset:3072
    ds_read_b64_tr_b16 v[102:103], v9 offset:4096
    buffer_load_dwordx4 v[124:127], v250, s[36:39], s96 offen sc1
    s_add_u32 s96, s96, 1024
    s_cmp_eq_u32 s96, 27648
    s_cselect_b32 s96, 0, s96
    s_add_u32 m0, s83, 12288
    v_mfma_f32_32x32x16_bf16 v[48:63], v[112:115], v[128:131], v[48:63]
    ds_read_b64_tr_b16 v[104:105], v10 offset:3072
    ds_read_b64_tr_b16 v[106:107], v10 offset:3584
    buffer_load_dwordx4 v220, s[28:31], s95 offen lds
    v_mfma_f32_32x32x16_bf16 v[64:79], v[112:115], v[132:135], v[64:79]
    buffer_load_dwordx4 v221, s[28:31], s95 offen offset:1024 lds
    s_add_u32 m0, s83, 14336
    v_mfma_f32_32x32x16_bf16 v[80:95], v[116:119], v[128:131], v[80:95]
    buffer_load_dwordx4 v222, s[28:31], s95 offen lds
    s_add_u32 s95, s95, 20480
    s_cmp_eq_u32 s95, s93
    s_cselect_b32 s95, s84, s95
    s_waitcnt vmcnt(13) lgkmcnt(0)
    v_mfma_f32_32x32x16_bf16 v[16:31], v[96:99], v[136:139], v[16:31]
    s_waitcnt vmcnt(10)
    ds_read_b64_tr_b16 v[108:109], v8 offset:6144
    ds_read_b64_tr_b16 v[110:111], v8 offset:7168
    buffer_load_dwordx4 v[128:131], v15, s[36:39], s96 offen sc1
    v_mfma_f32_32x32x16_bf16 v[32:47], v[96:99], v[140:143], v[32:47]
    ds_read_b64_tr_b16 v[112:113], v9 offset:6144
    ds_read_b64_tr_b16 v[114:115], v9 offset:7168
    buffer_load_dwordx4 v[132:135], v250, s[36:39], s96 offen sc1
    s_add_u32 s96, s96, 1024
    s_cmp_eq_u32 s96, 27648
    s_cselect_b32 s96, 0, s96
    s_add_u32 m0, s83, 15360
    v_mfma_f32_32x32x16_bf16 v[48:63], v[100:103], v[136:139], v[48:63]
    ds_read_b64_tr_b16 v[116:117], v10 offset:6144
    ds_read_b64_tr_b16 v[118:119], v10 offset:6656
    buffer_load_dwordx4 v220, s[28:31], s95 offen lds
    v_mfma_f32_32x32x16_bf16 v[64:79], v[100:103], v[140:143], v[64:79]
    buffer_load_dwordx4 v221, s[28:31], s95 offen offset:1024 lds
    s_add_u32 m0, s83, 17408
    v_mfma_f32_32x32x16_bf16 v[80:95], v[104:107], v[136:139], v[80:95]
    buffer_load_dwordx4 v222, s[28:31], s95 offen lds
    s_add_u32 s95, s95, 20480
    s_cmp_eq_u32 s95, s93
    s_cselect_b32 s95, s84, s95
    s_waitcnt vmcnt(13) lgkmcnt(0)
    v_mfma_f32_32x32x16_bf16 v[16:31], v[108:111], v[144:147], v[16:31]
    s_waitcnt vmcnt(10)
    ds_read_b64_tr_b16 v[96:97], v8 offset:9216
    ds_read_b64_tr_b16 v[98:99], v8 offset:10240
    buffer_load_dwordx4 v[136:139], v15, s[36:39], s96 offen sc1
    v_mfma_f32_32x32x16_bf16 v[32:47], v[108:111], v[148:151], v[32:47]
    ds_read_b64_tr_b16 v[100:101], v9 offset:9216
    ds_read_b64_tr_b16 v[102:103], v9 offset:10240
    buffer_load_dwordx4 v[140:143], v250, s[36:39], s96 offen sc1
    s_add_u32 s96, s96, 1024
    s_cmp_eq_u32 s96, 27648
    s_cselect_b32 s96, 0, s96
    s_add_u32 m0, s83, 18432
    v_mfma_f32_32x32x16_bf16 v[48:63], v[112:115], v[144:147], v[48:63]
    ds_read_b64_tr_b16 v[104:105], v10 offset:9216
    ds_read_b64_tr_b16 v[106:107], v10 offset:9728
    buffer_load_dwordx4 v220, s[28:31], s95 offen lds
    v_mfma_f32_32x32x16_bf16 v[64:79], v[112:115], v[148:151], v[64:79]
    buffer_load_dwordx4 v221, s[28:31], s95 offen offset:1024 lds
    s_add_u32 m0, s83, 20480
    v_mfma_f32_32x32x16_bf16 v[80:95], v[116:119], v[144:147], v[80:95]
    buffer_load_dwordx4 v222, s[28:31], s95 offen lds
    s_add_u32 s95, s95, 20480
    s_cmp_eq_u32 s95, s93
    s_cselect_b32 s95, s84, s95
    s_waitcnt vmcnt(13) lgkmcnt(0)
    v_mfma_f32_32x32x16_bf16 v[16:31], v[96:99], v[120:123], v[16:31]
    s_waitcnt vmcnt(10)
    ds_read_b64_tr_b16 v[108:109], v8 offset:12288
    ds_read_b64_tr_b16 v[110:111], v8 offset:13312
    buffer_load_dwordx4 v[144:147], v15, s[36:39], s96 offen sc1
    v_mfma_f32_32x32x16_bf16 v[32:47], v[96:99], v[124:127], v[32:47]
    ds_read_b64_tr_b16 v[112:113], v9 offset:12288
    ds_read_b64_tr_b16 v[114:115], v9 offset:13312
    buffer_load_dwordx4 v[148:151], v250, s[36:39], s96 offen sc1
    s_add_u32 s96, s96, 1024
    s_cmp_eq_u32 s96, 27648
    s_cselect_b32 s96, 0, s96
    s_add_u32 m0, s83, 21504
    v_mfma_f32_32x32x16_bf16 v[48:63], v[100:103], v[120:123], v[48:63]
    ds_read_b64_tr_b16 v[116:117], v10 offset:12288
    ds_read_b64_tr_b16 v[118:119], v10 offset:12800
    buffer_load_dwordx4 v220, s[28:31], s95 offen lds
    v_mfma_f32_32x32x16_bf16 v[64:79], v[100:103], v[124:127], v[64:79]
    buffer_load_dwordx4 v221, s[28:31], s95 offen offset:1024 lds
    s_add_u32 m0, s83, 23552
    v_mfma_f32_32x32x16_bf16 v[80:95], v[104:107], v[120:123], v[80:95]
    buffer_load_dwordx4 v222, s[28:31], s95 offen lds
    s_add_u32 s95, s95, 20480
    s_cmp_eq_u32 s95, s93
    s_cselect_b32 s95, s84, s95
    s_waitcnt vmcnt(13) lgkmcnt(0)
    v_mfma_f32_32x32x16_bf16 v[16:31], v[108:111], v[128:131], v[16:31]
    s_waitcnt vmcnt(10)
    ds_read_b64_tr_b16 v[96:97], v8 offset:15360
    ds_read_b64_tr_b16 v[98:99], v8 offset:16384
    buffer_load_dwordx4 v[120:123], v15, s[36:39], s96 offen sc1
    v_mfma_f32_32x32x16_bf16 v[32:47], v[108:111], v[132:135], v[32:47]
    ds_read_b64_tr_b16 v[100:101], v9 offset:15360
    ds_read_b64_tr_b16 v[102:103], v9 offset:16384
    buffer_load_dwordx4 v[124:127], v250, s[36:39], s96 offen sc1
    s_add_u32 s96, s96, 1024
    s_cmp_eq_u32 s96, 27648
    s_cselect_b32 s96, 0, s96
    s_add_u32 m0, s83, 24576
    v_mfma_f32_32x32x16_bf16 v[48:63], v[112:115], v[128:131], v[48:63]
    ds_read_b64_tr_b16 v[104:105], v10 offset:15360
    ds_read_b64_tr_b16 v[106:107], v10 offset:15872
    buffer_load_dwordx4 v220, s[28:31], s95 offen lds
    v_mfma_f32_32x32x16_bf16 v[64:79], v[112:115], v[132:135], v[64:79]
    buffer_load_dwordx4 v221, s[28:31], s95 offen offset:1024 lds
    s_add_u32 m0, s83, 26624
    v_mfma_f32_32x32x16_bf16 v[80:95], v[116:119], v[128:131], v[80:95]
    buffer_load_dwordx4 v222, s[28:31], s95 offen lds
    s_add_u32 s95, s95, 20480
    s_cmp_eq_u32 s95, s93
    s_cselect_b32 s95, s84, s95
    s_waitcnt vmcnt(13) lgkmcnt(0)
    v_mfma_f32_32x32x16_bf16 v[16:31], v[96:99], v[136:139], v[16:31]
    s_waitcnt vmcnt(10)
    ds_read_b64_tr_b16 v[108:109], v8 offset:18432
    ds_read_b64_tr_b16 v[110:111], v8 offset:19456
    buffer_load_dwordx4 v[128:131], v15, s[36:39], s96 offen sc1
    v_mfma_f32_32x32x16_bf16 v[32:47], v[96:99], v[140:143], v[32:47]
    ds_read_b64_tr_b16 v[112:113], v9 offset:18432
    ds_read_b64_tr_b16 v[114:115], v9 offset:19456
    buffer_load_dwordx4 v[132:135], v250, s[36:39], s96 offen sc1
    s_add_u32 s96, s96, 1024
    s_cmp_eq_u32 s96, 27648
    s_cselect_b32 s96, 0, s96
    s_add_u32 m0, s83, 0
    v_mfma_f32_32x32x16_bf16 v[48:63], v[100:103], v[136:139], v[48:63]
    ds_read_b64_tr_b16 v[116:117], v10 offset:18432
    ds_read_b64_tr_b16 v[118:119], v10 offset:18944
    buffer_load_dwordx4 v220, s[28:31], s95 offen lds
    v_mfma_f32_32x32x16_bf16 v[64:79], v[100:103], v[140:143], v[64:79]
    buffer_load_dwordx4 v221, s[28:31], s95 offen offset:1024 lds
    s_add_u32 m0, s83, 2048
    v_mfma_f32_32x32x16_bf16 v[80:95], v[104:107], v[136:139], v[80:95]
    buffer_load_dwordx4 v222, s[28:31], s95 offen lds
    s_add_u32 s95, s95, 20480
    s_cmp_eq_u32 s95, s93
    s_cselect_b32 s95, s84, s95
    s_waitcnt vmcnt(13) lgkmcnt(0)
    v_mfma_f32_32x32x16_bf16 v[16:31], v[108:111], v[144:147], v[16:31]
    s_waitcnt vmcnt(10)
    ds_read_b64_tr_b16 v[96:97], v8 offset:21504
    ds_read_b64_tr_b16 v[98:99], v8 offset:22528
    buffer_load_dwordx4 v[136:139], v15, s[36:39], s96 offen sc1
    v_mfma_f32_32x32x16_bf16 v[32:47], v[108:111], v[148:151], v[32:47]
    ds_read_b64_tr_b16 v[100:101], v9 offset:21504
    ds_read_b64_tr_b16 v[102:103], v9 offset:22528
    buffer_load_dwordx4 v[140:143], v250, s[36:39], s96 offen sc1
    s_add_u32 s96, s96, 1024
    s_cmp_eq_u32 s96, 27648
    s_cselect_b32 s96, 0, s96
    s_add_u32 m0, s83, 3072
    v_mfma_f32_32x32x16_bf16 v[48:63], v[112:115], v[144:147], v[48:63]
    ds_read_b64_tr_b16 v[104:105], v10 offset:21504
    ds_read_b64_tr_b16 v[106:107], v10 offset:22016
    buffer_load_dwordx4 v220, s[28:31], s95 offen lds
    v_mfma_f32_32x32x16_bf16 v[64:79], v[112:115], v[148:151], v[64:79]
    buffer_load_dwordx4 v221, s[28:31], s95 offen offset:1024 lds
    s_add_u32 m0, s83, 5120
    v_mfma_f32_32x32x16_bf16 v[80:95], v[116:119], v[144:147], v[80:95]
    buffer_load_dwordx4 v222, s[28:31], s95 offen lds
    s_add_u32 s95, s95, 20480
    s_cmp_eq_u32 s95, s93
    s_cselect_b32 s95, s84, s95
    s_waitcnt vmcnt(13) lgkmcnt(0)
    v_mfma_f32_32x32x16_bf16 v[16:31], v[96:99], v[120:123], v[16:31]
    s_waitcnt vmcnt(10)
    ds_read_b64_tr_b16 v[108:109], v8 offset:24576
    ds_read_b64_tr_b16 v[110:111], v8 offset:25600
    buffer_load_dwordx4 v[144:147], v15, s[36:39], s96 offen sc1
    v_mfma_f32_32x32x16_bf16 v[32:47], v[96:99], v[124:127], v[32:47]
    ds_read_b64_tr_b16 v[112:113], v9 offset:24576
    ds_read_b64_tr_b16 v[114:115], v9 offset:25600
    buffer_load_dwordx4 v[148:151], v250, s[36:39], s96 offen sc1
    s_add_u32 s96, s96, 1024
    s_cmp_eq_u32 s96, 27648
    s_cselect_b32 s96, 0, s96
    s_add_u32 m0, s83, 6144
    v_mfma_f32_32x32x16_bf16 v[48:63], v[100:103], v[120:123], v[48:63]
    ds_read_b64_tr_b16 v[116:117], v10 offset:24576
    ds_read_b64_tr_b16 v[118:119], v10 offset:25088
    buffer_load_dwordx4 v220, s[28:31], s95 offen lds
    v_mfma_f32_32x32x16_bf16 v[64:79], v[100:103], v[124:127], v[64:79]
    buffer_load_dwordx4 v221, s[28:31], s95 offen offset:1024 lds
    s_add_u32 m0, s83, 8192
    v_mfma_f32_32x32x16_bf16 v[80:95], v[104:107], v[120:123], v[80:95]
    buffer_load_dwordx4 v222, s[28:31], s95 offen lds
    s_add_u32 s95, s95, 20480
    s_cmp_eq_u32 s95, s93
    s_cselect_b32 s95, s84, s95
    s_waitcnt vmcnt(13) lgkmcnt(0)
    v_mfma_f32_32x32x16_bf16 v[16:31], v[108:111], v[128:131], v[16:31]
    s_waitcnt vmcnt(10)
    ds_read_b64_tr_b16 v[96:97], v8 offset:0
    ds_read_b64_tr_b16 v[98:99], v8 offset:1024
    buffer_load_dwordx4 v[120:123], v15, s[36:39], s96 offen sc1
    v_mfma_f32_32x32x16_bf16 v[32:47], v[108:111], v[132:135], v[32:47]
    ds_read_b64_tr_b16 v[100:101], v9 offset:0
    ds_read_b64_tr_b16 v[102:103], v9 offset:1024
    buffer_load_dwordx4 v[124:127], v250, s[36:39], s96 offen sc1
    s_add_u32 s96, s96, 1024
    s_cmp_eq_u32 s96, 27648
    s_cselect_b32 s96, 0, s96
    s_add_u32 m0, s83, 9216
    v_mfma_f32_32x32x16_bf16 v[48:63], v[112:115], v[128:131], v[48:63]
    ds_read_b64_tr_b16 v[104:105], v10 offset:0
    ds_read_b64_tr_b16 v[106:107], v10 offset:512
    buffer_load_dwordx4 v220, s[28:31], s95 offen lds
    v_mfma_f32_32x32x16_bf16 v[64:79], v[112:115], v[132:135], v[64:79]
    buffer_load_dwordx4 v221, s[28:31], s95 offen offset:1024 lds
    s_add_u32 m0, s83, 11264
    v_mfma_f32_32x32x16_bf16 v[80:95], v[116:119], v[128:131], v[80:95]
    buffer_load_dwordx4 v222, s[28:31], s95 offen lds
    s_add_u32 s95, s95, 20480
    s_cmp_eq_u32 s95, s93
    s_cselect_b32 s95, s84, s95
    s_waitcnt vmcnt(13) lgkmcnt(0)
    v_mfma_f32_32x32x16_bf16 v[16:31], v[96:99], v[136:139], v[16:31]
    s_waitcnt vmcnt(10)
    ds_read_b64_tr_b16 v[108:109], v8 offset:3072
    ds_read_b64_tr_b16 v[110:111], v8 offset:4096
    buffer_load_dwordx4 v[128:131], v15, s[36:39], s96 offen sc1
    v_mfma_f32_32x32x16_bf16 v[32:47], v[96:99], v[140:143], v[32:47]
    ds_read_b64_tr_b16 v[112:113], v9 offset:3072
    ds_read_b64_tr_b16 v[114:115], v9 offset:4096
    buffer_load_dwordx4 v[132:135], v250, s[36:39], s96 offen sc1
    s_add_u32 s96, s96, 1024
    s_cmp_eq_u32 s96, 27648
    s_cselect_b32 s96, 0, s96
    s_add_u32 m0, s83, 12288
    v_mfma_f32_32x32x16_bf16 v[48:63], v[100:103], v[136:139], v[48:63]
    ds_read_b64_tr_b16 v[116:117], v10 offset:3072
    ds_read_b64_tr_b16 v[118:119], v10 offset:3584
    buffer_load_dwordx4 v220, s[28:31], s95 offen lds
    v_mfma_f32_32x32x16_bf16 v[64:79], v[100:103], v[140:143], v[64:79]
    buffer_load_dwordx4 v221, s[28:31], s95 offen offset:1024 lds
    s_add_u32 m0, s83, 14336
    v_mfma_f32_32x32x16_bf16 v[80:95], v[104:107], v[136:139], v[80:95]
    buffer_load_dwordx4 v222, s[28:31], s95 offen lds
    s_add_u32 s95, s95, 20480
    s_cmp_eq_u32 s95, s93
    s_cselect_b32 s95, s84, s95
    s_waitcnt vmcnt(13) lgkmcnt(0)
    v_mfma_f32_32x32x16_bf16 v[16:31], v[108:111], v[144:147], v[16:31]
    s_waitcnt vmcnt(10)
    ds_read_b64_tr_b16 v[96:97], v8 offset:6144
    ds_read_b64_tr_b16 v[98:99], v8 offset:7168
    buffer_load_dwordx4 v[136:139], v15, s[36:39], s96 offen sc1
    v_mfma_f32_32x32x16_bf16 v[32:47], v[108:111], v[148:151], v[32:47]
    ds_read_b64_tr_b16 v[100:101], v9 offset:6144
    ds_read_b64_tr_b16 v[102:103], v9 offset:7168
    buffer_load_dwordx4 v[140:143], v250, s[36:39], s96 offen sc1
    s_add_u32 s96, s96, 1024
    s_cmp_eq_u32 s96, 27648
    s_cselect_b32 s96, 0, s96
    s_add_u32 m0, s83, 15360
    v_mfma_f32_32x32x16_bf16 v[48:63], v[112:115], v[144:147], v[48:63]
    ds_read_b64_tr_b16 v[104:105], v10 offset:6144
    ds_read_b64_tr_b16 v[106:107], v10 offset:6656
    buffer_load_dwordx4 v220, s[28:31], s95 offen lds
    v_mfma_f32_32x32x16_bf16 v[64:79], v[112:115], v[148:151], v[64:79]
    buffer_load_dwordx4 v221, s[28:31], s95 offen offset:1024 lds
    s_add_u32 m0, s83, 17408
    v_mfma_f32_32x32x16_bf16 v[80:95], v[116:119], v[144:147], v[80:95]
    buffer_load_dwordx4 v222, s[28:31], s95 offen lds
    s_add_u32 s95, s95, 20480
    s_cmp_eq_u32 s95, s93
    s_cselect_b32 s95, s84, s95
    s_waitcnt vmcnt(13) lgkmcnt(0)
    v_mfma_f32_32x32x16_bf16 v[16:31], v[96:99], v[120:123], v[16:31]
    s_waitcnt vmcnt(10)
    ds_read_b64_tr_b16 v[108:109], v8 offset:9216
    ds_read_b64_tr_b16 v[110:111], v8 offset:10240
    buffer_load_dwordx4 v[144:147], v15, s[36:39], s96 offen sc1
    v_mfma_f32_32x32x16_bf16 v[32:47], v[96:99], v[124:127], v[32:47]
    ds_read_b64_tr_b16 v[112:113], v9 offset:9216
    ds_read_b64_tr_b16 v[114:115], v9 offset:10240
    buffer_load_dwordx4 v[148:151], v250, s[36:39], s96 offen sc1
    s_add_u32 s96, s96, 1024
    s_cmp_eq_u32 s96, 27648
    s_cselect_b32 s96, 0, s96
    s_add_u32 m0, s83, 18432
    v_mfma_f32_32x32x16_bf16 v[48:63], v[100:103], v[120:123], v[48:63]
    ds_read_b64_tr_b16 v[116:117], v10 offset:9216
    ds_read_b64_tr_b16 v[118:119], v10 offset:9728
    buffer_load_dwordx4 v220, s[28:31], s95 offen lds
    v_mfma_f32_32x32x16_bf16 v[64:79], v[100:103], v[124:127], v[64:79]
    buffer_load_dwordx4 v221, s[28:31], s95 offen offset:1024 lds
    s_add_u32 m0, s83, 20480
    v_mfma_f32_32x32x16_bf16 v[80:95], v[104:107], v[120:123], v[80:95]
    buffer_load_dwordx4 v222, s[28:31], s95 offen lds
    s_add_u32 s95, s95, 20480
    s_cmp_eq_u32 s95, s93
    s_cselect_b32 s95, s84, s95
    s_waitcnt vmcnt(13) lgkmcnt(0)
    v_mfma_f32_32x32x16_bf16 v[16:31], v[108:111], v[128:131], v[16:31]
    s_waitcnt vmcnt(10)
    ds_read_b64_tr_b16 v[96:97], v8 offset:12288
    ds_read_b64_tr_b16 v[98:99], v8 offset:13312
    buffer_load_dwordx4 v[120:123], v15, s[36:39], s96 offen sc1
    v_mfma_f32_32x32x16_bf16 v[32:47], v[108:111], v[132:135], v[32:47]
    ds_read_b64_tr_b16 v[100:101], v9 offset:12288
    ds_read_b64_tr_b16 v[102:103], v9 offset:13312
    buffer_load_dwordx4 v[124:127], v250, s[36:39], s96 offen sc1
    s_add_u32 s96, s96, 1024
    s_cmp_eq_u32 s96, 27648
    s_cselect_b32 s96, 0, s96
    s_add_u32 m0, s83, 21504
    v_mfma_f32_32x32x16_bf16 v[48:63], v[112:115], v[128:131], v[48:63]
    ds_read_b64_tr_b16 v[104:105], v10 offset:12288
    ds_read_b64_tr_b16 v[106:107], v10 offset:12800
    buffer_load_dwordx4 v220, s[28:31], s95 offen lds
    v_mfma_f32_32x32x16_bf16 v[64:79], v[112:115], v[132:135], v[64:79]
    buffer_load_dwordx4 v221, s[28:31], s95 offen offset:1024 lds
    s_add_u32 m0, s83, 23552
    v_mfma_f32_32x32x16_bf16 v[80:95], v[116:119], v[128:131], v[80:95]
    buffer_load_dwordx4 v222, s[28:31], s95 offen lds
    s_add_u32 s95, s95, 20480
    s_cmp_eq_u32 s95, s93
    s_cselect_b32 s95, s84, s95
    s_waitcnt vmcnt(13) lgkmcnt(0)
    v_mfma_f32_32x32x16_bf16 v[16:31], v[96:99], v[136:139], v[16:31]
    s_waitcnt vmcnt(10)
    ds_read_b64_tr_b16 v[108:109], v8 offset:15360
    ds_read_b64_tr_b16 v[110:111], v8 offset:16384
    buffer_load_dwordx4 v[128:131], v15, s[36:39], s96 offen sc1
    v_mfma_f32_32x32x16_bf16 v[32:47], v[96:99], v[140:143], v[32:47]
    ds_read_b64_tr_b16 v[112:113], v9 offset:15360
    ds_read_b64_tr_b16 v[114:115], v9 offset:16384
    buffer_load_dwordx4 v[132:135], v250, s[36:39], s96 offen sc1
    s_add_u32 s96, s96, 1024
    s_cmp_eq_u32 s96, 27648
    s_cselect_b32 s96, 0, s96
    s_add_u32 m0, s83, 24576
    v_mfma_f32_32x32x16_bf16 v[48:63], v[100:103], v[136:139], v[48:63]
    ds_read_b64_tr_b16 v[116:117], v10 offset:15360
    ds_read_b64_tr_b16 v[118:119], v10 offset:15872
    buffer_load_dwordx4 v220, s[28:31], s95 offen lds
    v_mfma_f32_32x32x16_bf16 v[64:79], v[100:103], v[140:143], v[64:79]
    buffer_load_dwordx4 v221, s[28:31], s95 offen offset:1024 lds
    s_add_u32 m0, s83, 26624
    v_mfma_f32_32x32x16_bf16 v[80:95], v[104:107], v[136:139], v[80:95]
    buffer_load_dwordx4 v222, s[28:31], s95 offen lds
    s_add_u32 s95, s95, 20480
    s_cmp_eq_u32 s95, s93
    s_cselect_b32 s95, s84, s95
    s_waitcnt vmcnt(13) lgkmcnt(0)
    v_mfma_f32_32x32x16_bf16 v[16:31], v[108:111], v[144:147], v[16:31]
    s_waitcnt vmcnt(10)
    ds_read_b64_tr_b16 v[96:97], v8 offset:18432
    ds_read_b64_tr_b16 v[98:99], v8 offset:19456
    buffer_load_dwordx4 v[136:139], v15, s[36:39], s96 offen sc1
    v_mfma_f32_32x32x16_bf16 v[32:47], v[108:111], v[148:151], v[32:47]
    ds_read_b64_tr_b16 v[100:101], v9 offset:18432
    ds_read_b64_tr_b16 v[102:103], v9 offset:19456
    buffer_load_dwordx4 v[140:143], v250, s[36:39], s96 offen sc1
    s_add_u32 s96, s96, 1024
    s_cmp_eq_u32 s96, 27648
    s_cselect_b32 s96, 0, s96
    v_mfma_f32_32x32x16_bf16 v[48:63], v[112:115], v[144:147], v[48:63]
    ds_read_b64_tr_b16 v[104:105], v10 offset:18432
    ds_read_b64_tr_b16 v[106:107], v10 offset:18944
    v_mfma_f32_32x32x16_bf16 v[64:79], v[112:115], v[148:151], v[64:79]
    v_mfma_f32_32x32x16_bf16 v[80:95], v[116:119], v[144:147], v[80:95]
    s_waitcnt vmcnt(10) lgkmcnt(0)
    v_mfma_f32_32x32x16_bf16 v[16:31], v[96:99], v[120:123], v[16:31]
    s_waitcnt vmcnt(7)
    ds_read_b64_tr_b16 v[108:109], v8 offset:21504
    ds_read_b64_tr_b16 v[110:111], v8 offset:22528
    v_mfma_f32_32x32x16_bf16 v[32:47], v[96:99], v[124:127], v[32:47]
    ds_read_b64_tr_b16 v[112:113], v9 offset:21504
    ds_read_b64_tr_b16 v[114:115], v9 offset:22528
    v_mfma_f32_32x32x16_bf16 v[48:63], v[100:103], v[120:123], v[48:63]
    ds_read_b64_tr_b16 v[116:117], v10 offset:21504
    ds_read_b64_tr_b16 v[118:119], v10 offset:22016
    v_mfma_f32_32x32x16_bf16 v[64:79], v[100:103], v[124:127], v[64:79]
    v_mfma_f32_32x32x16_bf16 v[80:95], v[104:107], v[120:123], v[80:95]
    s_waitcnt vmcnt(5) lgkmcnt(0)
    v_mfma_f32_32x32x16_bf16 v[16:31], v[108:111], v[128:131], v[16:31]
    s_waitcnt vmcnt(2)
    ds_read_b64_tr_b16 v[96:97], v8 offset:24576
    ds_read_b64_tr_b16 v[98:99], v8 offset:25600
    v_mfma_f32_32x32x16_bf16 v[32:47], v[108:111], v[132:135], v[32:47]
    ds_read_b64_tr_b16 v[100:101], v9 offset:24576
    ds_read_b64_tr_b16 v[102:103], v9 offset:25600
    v_mfma_f32_32x32x16_bf16 v[48:63], v[112:115], v[128:131], v[48:63]
    ds_read_b64_tr_b16 v[104:105], v10 offset:24576
    ds_read_b64_tr_b16 v[106:107], v10 offset:25088
    v_mfma_f32_32x32x16_bf16 v[64:79], v[112:115], v[132:135], v[64:79]
    v_mfma_f32_32x32x16_bf16 v[80:95], v[116:119], v[128:131], v[80:95]
    s_waitcnt vmcnt(0) lgkmcnt(0)
    v_mfma_f32_32x32x16_bf16 v[16:31], v[96:99], v[136:139], v[16:31]
    v_mfma_f32_32x32x16_bf16 v[32:47], v[96:99], v[140:143], v[32:47]
    v_mfma_f32_32x32x16_bf16 v[48:63], v[100:103], v[136:139], v[48:63]
    v_mfma_f32_32x32x16_bf16 v[64:79], v[100:103], v[140:143], v[64:79]
    v_mfma_f32_32x32x16_bf16 v[80:95], v[104:107], v[136:139], v[80:95]
    s_setprio 3
    s_nop 7
    ds_write_b128 v11, v[16:19] offset:0
    ds_write_b128 v11, v[20:23] offset:1024
    ds_write_b128 v11, v[24:27] offset:2048
    ds_write_b128 v11, v[28:31] offset:3072
    ds_write_b128 v11, v[32:35] offset:4096
    ds_write_b128 v11, v[36:39] offset:5120
    ds_write_b128 v11, v[40:43] offset:6144
    ds_write_b128 v11, v[44:47] offset:7168
    ds_write_b128 v11, v[48:51] offset:8192
    ds_write_b128 v11, v[52:55] offset:9216
    ds_write_b128 v11, v[56:59] offset:10240
    ds_write_b128 v11, v[60:63] offset:11264
    ds_write_b128 v11, v[64:67] offset:12288
    ds_write_b128 v11, v[68:71] offset:13312
    s_waitcnt lgkmcnt(7)
    ds_write_b128 v11, v[72:75] offset:14336
    ds_write_b128 v11, v[76:79] offset:15360
    ds_write_b128 v11, v[80:83] offset:16384
    ds_write_b128 v11, v[84:87] offset:17408
    ds_write_b128 v11, v[88:91] offset:18432
    ds_write_b128 v11, v[92:95] offset:19456
    s_waitcnt lgkmcnt(0)
    ds_add_u32 v242, v244 offset:28
    s_mov_b32 s62, 0
L_spin_68:
    ds_read_b32 v246, v243 offset:28
    s_waitcnt lgkmcnt(0)
    v_cmp_gt_u32 vcc, 4, v246
    s_cbranch_vccz L_spind_69
    s_add_u32 s62, s62, 1
    s_cmp_lt_u32 s62, 400000
    s_cbranch_scc1 L_spin_68
L_spind_69:
    ds_read_b128 v[16:19], v12 offset:0
    ds_read_b128 v[20:23], v12 offset:1024
    ds_read_b128 v[24:27], v12 offset:2048
    ds_read_b128 v[28:31], v12 offset:3072
    ds_read_b128 v[32:35], v254 offset:0
    ds_read_b128 v[36:39], v12 offset:29696
    ds_read_b128 v[40:43], v12 offset:30720
    ds_read_b128 v[44:47], v12 offset:31744
    ds_read_b128 v[48:51], v12 offset:32768
    ds_read_b128 v[52:55], v254 offset:29696
    ds_read_b128 v[56:59], v13 offset:0
    ds_read_b128 v[60:63], v13 offset:1024
    ds_read_b128 v[64:67], v13 offset:2048
    ds_read_b128 v[68:71], v13 offset:3072
    ds_read_b128 v[72:75], v255 offset:0
    s_waitcnt lgkmcnt(5)
    ds_read_b128 v[76:79], v13 offset:29696
    ds_read_b128 v[80:83], v13 offset:30720
    ds_read_b128 v[84:87], v13 offset:31744
    ds_read_b128 v[88:91], v13 offset:32768
    ds_read_b128 v[92:95], v255 offset:29696
    v_pk_add_f32 v[200:201], v[16:17], v[36:37]
    v_pk_add_f32 v[202:203], v[18:19], v[38:39]
    v_pk_add_f32 v[204:205], v[20:21], v[40:41]
    v_pk_add_f32 v[206:207], v[22:23], v[42:43]
    v_pk_add_f32 v[208:209], v[24:25], v[44:45]
    v_pk_add_f32 v[210:211], v[26:27], v[46:47]
    v_pk_add_f32 v[212:213], v[28:29], v[48:49]
    v_pk_add_f32 v[214:215], v[30:31], v[50:51]
    v_pk_add_f32 v[216:217], v[32:33], v[52:53]
    v_pk_add_f32 v[218:219], v[34:35], v[54:55]
    s_waitcnt lgkmcnt(5)
    v_pk_add_f32 v[200:201], v[200:201], v[56:57]
    v_pk_add_f32 v[202:203], v[202:203], v[58:59]
    v_pk_add_f32 v[204:205], v[204:205], v[60:61]
    v_pk_add_f32 v[206:207], v[206:207], v[62:63]
    v_pk_add_f32 v[208:209], v[208:209], v[64:65]
    v_pk_add_f32 v[210:211], v[210:211], v[66:67]
    v_pk_add_f32 v[212:213], v[212:213], v[68:69]
    v_pk_add_f32 v[214:215], v[214:215], v[70:71]
    v_pk_add_f32 v[216:217], v[216:217], v[72:73]
    v_pk_add_f32 v[218:219], v[218:219], v[74:75]
    s_waitcnt lgkmcnt(0)
    v_pk_add_f32 v[200:201], v[200:201], v[76:77]
    v_pk_add_f32 v[202:203], v[202:203], v[78:79]
    v_pk_add_f32 v[204:205], v[204:205], v[80:81]
    v_pk_add_f32 v[206:207], v[206:207], v[82:83]
    v_pk_add_f32 v[208:209], v[208:209], v[84:85]
    v_pk_add_f32 v[210:211], v[210:211], v[86:87]
    v_pk_add_f32 v[212:213], v[212:213], v[88:89]
    v_pk_add_f32 v[214:215], v[214:215], v[90:91]
    v_pk_add_f32 v[216:217], v[216:217], v[92:93]
    v_pk_add_f32 v[218:219], v[218:219], v[94:95]
    v_mov_b32 v40, 0xbfb8aa3b
    v_mov_b32 v41, v40
    v_mov_b32 v42, 1.0
    v_mov_b32 v43, 1.0
    v_pk_mul_f32 v[16:17], v[200:201], v[40:41]
    v_pk_mul_f32 v[18:19], v[202:203], v[40:41]
    v_pk_mul_f32 v[20:21], v[204:205], v[40:41]
    v_pk_mul_f32 v[22:23], v[206:207], v[40:41]
    v_pk_mul_f32 v[24:25], v[208:209], v[40:41]
    v_pk_mul_f32 v[26:27], v[210:211], v[40:41]
    v_pk_mul_f32 v[28:29], v[212:213], v[40:41]
    v_pk_mul_f32 v[30:31], v[214:215], v[40:41]
    v_pk_mul_f32 v[32:33], v[216:217], v[40:41]
    v_pk_mul_f32 v[34:35], v[218:219], v[40:41]
    v_exp_f32 v16, v16
    v_exp_f32 v17, v17
    v_exp_f32 v18, v18
    v_exp_f32 v19, v19
    v_exp_f32 v20, v20
    v_exp_f32 v21, v21
    v_exp_f32 v22, v22
    v_exp_f32 v23, v23
    v_exp_f32 v24, v24
    v_exp_f32 v25, v25
    v_exp_f32 v26, v26
    v_exp_f32 v27, v27
    v_exp_f32 v28, v28
    v_exp_f32 v29, v29
    v_exp_f32 v30, v30
    v_exp_f32 v31, v31
    v_exp_f32 v32, v32
    v_exp_f32 v33, v33
    v_exp_f32 v34, v34
    v_exp_f32 v35, v35
    v_pk_add_f32 v[16:17], v[16:17], v[42:43]
    v_pk_add_f32 v[18:19], v[18:19], v[42:43]
    v_pk_add_f32 v[20:21], v[20:21], v[42:43]
    v_pk_add_f32 v[22:23], v[22:23], v[42:43]
    v_pk_add_f32 v[24:25], v[24:25], v[42:43]
    v_pk_add_f32 v[26:27], v[26:27], v[42:43]
    v_pk_add_f32 v[28:29], v[28:29], v[42:43]
    v_pk_add_f32 v[30:31], v[30:31], v[42:43]
    v_pk_add_f32 v[32:33], v[32:33], v[42:43]
    v_pk_add_f32 v[34:35], v[34:35], v[42:43]
    v_rcp_f32 v16, v16
    v_rcp_f32 v17, v17
    v_rcp_f32 v18, v18
    v_rcp_f32 v19, v19
    v_rcp_f32 v20, v20
    v_rcp_f32 v21, v21
    v_rcp_f32 v22, v22
    v_rcp_f32 v23, v23
    v_rcp_f32 v24, v24
    v_rcp_f32 v25, v25
    v_rcp_f32 v26, v26
    v_rcp_f32 v27, v27
    v_rcp_f32 v28, v28
    v_rcp_f32 v29, v29
    v_rcp_f32 v30, v30
    v_rcp_f32 v31, v31
    v_rcp_f32 v32, v32
    v_rcp_f32 v33, v33
    v_rcp_f32 v34, v34
    v_rcp_f32 v35, v35
    v_pk_mul_f32 v[200:201], v[200:201], v[16:17]
    v_pk_mul_f32 v[202:203], v[202:203], v[18:19]
    v_pk_mul_f32 v[204:205], v[204:205], v[20:21]
    v_pk_mul_f32 v[206:207], v[206:207], v[22:23]
    v_pk_mul_f32 v[208:209], v[208:209], v[24:25]
    v_pk_mul_f32 v[210:211], v[210:211], v[26:27]
    v_pk_mul_f32 v[212:213], v[212:213], v[28:29]
    v_pk_mul_f32 v[214:215], v[214:215], v[30:31]
    v_pk_mul_f32 v[216:217], v[216:217], v[32:33]
    v_pk_mul_f32 v[218:219], v[218:219], v[34:35]
    s_setprio 0
    ds_add_u32 v242, v244 offset:28
    s_mov_b32 s62, 0
L_spin_70:
    ds_read_b32 v246, v243 offset:28
    s_waitcnt lgkmcnt(0)
    v_cmp_gt_u32 vcc, 8, v246
    s_cbranch_vccz L_spind_71
    s_add_u32 s62, s62, 1
    s_cmp_lt_u32 s62, 400000
    s_sleep 1
    s_cbranch_scc1 L_spin_70
L_spind_71:
    s_lshl_b32 s62, s7, 1
    s_add_u32 s93, s62, s82
    s_xor_b32 s63, s82, 1
    s_add_u32 s94, s62, s63
    s_mul_i32 s84, s93, 102400
    s_mul_i32 s87, s94, 102400
    s_add_u32 s67, s84, 0
    s_add_u32 m0, s83, 0
    s_nop 0
    buffer_load_dwordx4 v220, s[20:23], s67 offen lds
    buffer_load_dwordx4 v221, s[20:23], s67 offen offset:1024 lds
    s_add_u32 m0, s83, 2048
    s_nop 0
    buffer_load_dwordx4 v222, s[20:23], s67 offen lds
    s_add_u32 s67, s84, 25600
    s_add_u32 m0, s83, 3072
    s_nop 0
    buffer_load_dwordx4 v220, s[20:23], s67 offen lds
    buffer_load_dwordx4 v221, s[20:23], s67 offen offset:1024 lds
    s_add_u32 m0, s83, 5120
    s_nop 0
    buffer_load_dwordx4 v222, s[20:23], s67 offen lds
    s_add_u32 s67, s84, 51200
    s_add_u32 m0, s83, 6144
    s_nop 0
    buffer_load_dwordx4 v220, s[20:23], s67 offen lds
    buffer_load_dwordx4 v221, s[20:23], s67 offen offset:1024 lds
    s_add_u32 m0, s83, 8192
    s_nop 0
    buffer_load_dwordx4 v222, s[20:23], s67 offen lds
    s_waitcnt vmcnt(6)
    s_add_u32 s67, s84, 76800
    s_add_u32 m0, s83, 9216
    s_nop 0
    buffer_load_dwordx4 v220, s[20:23], s67 offen lds
    buffer_load_dwordx4 v221, s[20:23], s67 offen offset:1024 lds
    s_add_u32 m0, s83, 11264
    s_nop 0
    buffer_load_dwordx4 v222, s[20:23], s67 offen lds
    s_waitcnt vmcnt(6)
    s_add_u32 m0, s83, 12288
    s_nop 0
    buffer_load_dwordx4 v223, s[20:23], s84 offen lds
    buffer_load_dwordx4 v224, s[20:23], s84 offen offset:1024 lds
    s_add_u32 m0, s83, 14336
    s_nop 0
    buffer_load_dwordx4 v225, s[20:23], s84 offen lds
    s_waitcnt vmcnt(6)
    s_add_u32 s67, s87, 0
    s_add_u32 m0, s83, 15360
    s_nop 0
    buffer_load_dwordx4 v220, s[20:23], s67 offen lds
    buffer_load_dwordx4 v221, s[20:23], s67 offen offset:1024 lds
    s_add_u32 m0, s83, 17408
    s_nop 0
    buffer_load_dwordx4 v222, s[20:23], s67 offen lds
    s_waitcnt vmcnt(6)
    s_add_u32 s67, s87, 25600
    s_add_u32 m0, s83, 18432
    s_nop 0
    buffer_load_dwordx4 v220, s[20:23], s67 offen lds
    buffer_load_dwordx4 v221, s[20:23], s67 offen offset:1024 lds
    s_add_u32 m0, s83, 20480
    s_nop 0
    buffer_load_dwordx4 v222, s[20:23], s67 offen lds
    s_waitcnt vmcnt(6)
    s_add_u32 s67, s87, 51200
    s_add_u32 m0, s83, 21504
    s_nop 0
    buffer_load_dwordx4 v220, s[20:23], s67 offen lds
    buffer_load_dwordx4 v221, s[20:23], s67 offen offset:1024 lds
    s_add_u32 m0, s83, 23552
    s_nop 0
    buffer_load_dwordx4 v222, s[20:23], s67 offen lds
    s_waitcnt vmcnt(6)
    s_add_u32 s67, s87, 76800
    s_add_u32 m0, s83, 24576
    s_nop 0
    buffer_load_dwordx4 v220, s[20:23], s67 offen lds
    buffer_load_dwordx4 v221, s[20:23], s67 offen offset:1024 lds
    s_add_u32 m0, s83, 26624
    s_nop 0
    buffer_load_dwordx4 v222, s[20:23], s67 offen lds
    s_waitcnt vmcnt(6)
    s_waitcnt vmcnt(0)
    ds_read_b64_tr_b16 v[96:97], v8 offset:0
    ds_read_b64_tr_b16 v[98:99], v8 offset:1024
    ds_read_b64_tr_b16 v[100:101], v9 offset:0
    ds_read_b64_tr_b16 v[102:103], v9 offset:1024
    ds_read_b64_tr_b16 v[104:105], v10 offset:0
    ds_read_b64_tr_b16 v[106:107], v10 offset:512
    s_waitcnt lgkmcnt(0)
    s_add_u32 m0, s83, 0
    s_nop 0
    buffer_load_dwordx4 v223, s[20:23], s87 offen lds
    buffer_load_dwordx4 v224, s[20:23], s87 offen offset:1024 lds
    s_add_u32 m0, s83, 2048
    s_nop 0
    buffer_load_dwordx4 v225, s[20:23], s87 offen lds
    s_waitcnt vmcnt(0)
    s_lshr_b32 s62, s7, 1
    s_lshl_b32 s62, s62, 6
    s_add_u32 s62, s62, s80
    s_and_b32 s63, s7, 1
    s_xor_b32 s63, s63, s82
    s_lshl_b32 s64, s4, 1
    s_add_u32 s63, s63, s64
    s_mul_i32 s63, s63, 40960
    s_add_u32 s88, s62, s63
    s_add_u32 s64, s64, s82
    s_mul_i32 s64, s64, 40960
    s_lshl_b32 s62, s7, 4
    s_add_u32 s64, s64, s62
    s_add_u32 s89, s64, s81
    buffer_load_dwordx2 v[220:221], v14, s[8:11], s88 offen offset:0
    buffer_load_dwordx2 v[222:223], v14, s[8:11], s88 offen offset:16
    buffer_load_dwordx2 v[224:225], v14, s[8:11], s88 offen offset:32
    buffer_load_dwordx2 v[226:227], v14, s[8:11], s88 offen offset:48
    buffer_load_dwordx2 v[228:229], v14, s[8:11], s89 offen
    s_cmp_lg_u32 s7, 0
    s_cbranch_scc1 L_opw_72
    s_mov_b32 s62, 0
L_spin_74:
    ds_read_b32 v246, v243 offset:0
    s_waitcnt lgkmcnt(0)
    v_cmp_gt_u32 vcc, 68, v246
    s_cbranch_vccz L_spind_75
    s_add_u32 s62, s62, 1
    s_cmp_lt_u32 s62, 400000
    s_sleep 8
    s_cbranch_scc1 L_spin_74
L_spind_75:
    s_mov_b32 s62, 0
L_spin_76:
    ds_read_b32 v246, v243 offset:32
    s_waitcnt lgkmcnt(0)
    v_cmp_gt_u32 vcc, 4, v246
    s_cbranch_vccz L_spind_77
    s_add_u32 s62, s62, 1
    s_cmp_lt_u32 s62, 400000
    s_sleep 1
    s_cbranch_scc1 L_spin_76
L_spind_77:
    v_and_b32 v246, 7, v0
    v_lshlrev_b32 v246, 2, v246
    s_lshl_b32 s63, s4, 7
    s_add_u32 s63, s63, 24576
    s_mov_b32 s62, 0
L_poll_78:
    buffer_load_dword v247, v246, s[36:39], s63 offen sc1
    s_waitcnt vmcnt(0)
    v_cmp_ne_u32 vcc, s6, v247
    s_cbranch_vccz L_polld_79
    s_add_u32 s62, s62, 1
    s_cmp_lt_u32 s62, 40000
    s_sleep 1
    s_cbranch_scc1 L_poll_78
L_polld_79:
    ds_add_u32 v242, v244 offset:44
    s_branch L_opj_73
L_opw_72:
    s_mov_b32 s62, 0
L_spin_80:
    ds_read_b32 v246, v243 offset:44
    s_waitcnt lgkmcnt(0)
    v_cmp_gt_u32 vcc, 1, v246
    s_cbranch_vccz L_spind_81
    s_add_u32 s62, s62, 1
    s_cmp_lt_u32 s62, 400000
    s_sleep 3
    s_cbranch_scc1 L_spin_80
L_spind_81:
L_opj_73:
    s_waitcnt lgkmcnt(0)
    s_lshl_b32 s62, s4, 1
    s_add_u32 s63, s62, s82
    s_xor_b32 s64, s82, 1
    s_add_u32 s64, s62, s64
    s_mul_i32 s85, s63, 40960
    s_mul_i32 s86, s64, 40960
    s_add_u32 s85, s85, 8388608
    s_add_u32 s86, s86, 8388608
    s_mul_i32 s93, s93, 5120
    s_mul_i32 s94, s94, 5120
    s_add_u32 s62, s85, s93
    buffer_load_dwordx4 v[120:123], v245, s[36:39], s62 offen offset:0 sc1
    s_add_u32 s63, s86, s93
    buffer_load_dwordx4 v[124:127], v245, s[36:39], s63 offen offset:0 sc1
    s_add_u32 s62, s85, s93
    buffer_load_dwordx4 v[128:131], v245, s[36:39], s62 offen offset:1024 sc1
    s_add_u32 s63, s86, s93
    buffer_load_dwordx4 v[132:135], v245, s[36:39], s63 offen offset:1024 sc1
    s_add_u32 s62, s85, s93
    buffer_load_dwordx4 v[136:139], v245, s[36:39], s62 offen offset:2048 sc1
    s_add_u32 s63, s86, s93
    buffer_load_dwordx4 v[140:143], v245, s[36:39], s63 offen offset:2048 sc1
    s_add_u32 s62, s85, s93
    buffer_load_dwordx4 v[144:147], v245, s[36:39], s62 offen offset:3072 sc1
    s_add_u32 s63, s86, s93
    buffer_load_dwordx4 v[148:151], v245, s[36:39], s63 offen offset:3072 sc1
    s_add_u32 s62, s85, s93
    s_add_u32 s62, s62, 4096
    buffer_load_dwordx4 v[152:155], v245, s[36:39], s62 offen sc1
    s_add_u32 s63, s86, s93
    s_add_u32 s63, s63, 4096
    buffer_load_dwordx4 v[156:159], v245, s[36:39], s63 offen sc1
    s_add_u32 s62, s85, s94
    buffer_load_dwordx4 v[160:163], v245, s[36:39], s62 offen offset:0 sc1
    s_add_u32 s63, s86, s94
    buffer_load_dwordx4 v[164:167], v245, s[36:39], s63 offen offset:0 sc1
    s_add_u32 s62, s85, s94
    buffer_load_dwordx4 v[168:171], v245, s[36:39], s62 offen offset:1024 sc1
    s_add_u32 s63, s86, s94
    buffer_load_dwordx4 v[172:175], v245, s[36:39], s63 offen offset:1024 sc1
    s_add_u32 s62, s85, s94
    buffer_load_dwordx4 v[176:179], v245, s[36:39], s62 offen offset:2048 sc1
    s_add_u32 s63, s86, s94
    buffer_load_dwordx4 v[180:183], v245, s[36:39], s63 offen offset:2048 sc1
    s_add_u32 s62, s85, s94
    buffer_load_dwordx4 v[184:187], v245, s[36:39], s62 offen offset:3072 sc1
    s_add_u32 s63, s86, s94
    buffer_load_dwordx4 v[188:191], v245, s[36:39], s63 offen offset:3072 sc1
    s_add_u32 s62, s85, s94
    s_add_u32 s62, s62, 4096
    buffer_load_dwordx4 v[192:195], v245, s[36:39], s62 offen sc1
    s_add_u32 s63, s86, s94
    s_add_u32 s63, s63, 4096
    buffer_load_dwordx4 v[196:199], v245, s[36:39], s63 offen sc1
    s_waitcnt vmcnt(18)
    v_mfma_f32_32x32x16_bf16 v[16:31], v[96:99], v[120:123], 0
    ds_read_b64_tr_b16 v[108:109], v8 offset:3072
    ds_read_b64_tr_b16 v[110:111], v8 offset:4096
    ds_read_b64_tr_b16 v[112:113], v9 offset:3072
    v_mfma_f32_32x32x16_bf16 v[32:47], v[96:99], v[124:127], 0
    ds_read_b64_tr_b16 v[114:115], v9 offset:4096
    ds_read_b64_tr_b16 v[116:117], v10 offset:3072
    ds_read_b64_tr_b16 v[118:119], v10 offset:3584
    v_mfma_f32_32x32x16_bf16 v[48:63], v[100:103], v[120:123], 0
    v_mfma_f32_32x32x16_bf16 v[64:79], v[100:103], v[124:127], 0
    v_mfma_f32_32x32x16_bf16 v[80:95], v[104:107], v[120:123], 0
    s_waitcnt vmcnt(16) lgkmcnt(0)
    v_mfma_f32_32x32x16_bf16 v[16:31], v[108:111], v[128:131], v[16:31]
    ds_read_b64_tr_b16 v[96:97], v8 offset:6144
    ds_read_b64_tr_b16 v[98:99], v8 offset:7168
    ds_read_b64_tr_b16 v[100:101], v9 offset:6144
    v_mfma_f32_32x32x16_bf16 v[32:47], v[108:111], v[132:135], v[32:47]
    ds_read_b64_tr_b16 v[102:103], v9 offset:7168
    ds_read_b64_tr_b16 v[104:105], v10 offset:6144
    ds_read_b64_tr_b16 v[106:107], v10 offset:6656
    v_mfma_f32_32x32x16_bf16 v[48:63], v[112:115], v[128:131], v[48:63]
    v_mfma_f32_32x32x16_bf16 v[64:79], v[112:115], v[132:135], v[64:79]
    v_mfma_f32_32x32x16_bf16 v[80:95], v[116:119], v[128:131], v[80:95]
    s_waitcnt vmcnt(14) lgkmcnt(0)
    v_mfma_f32_32x32x16_bf16 v[16:31], v[96:99], v[136:139], v[16:31]
    ds_read_b64_tr_b16 v[108:109], v8 offset:9216
    ds_read_b64_tr_b16 v[110:111], v8 offset:10240
    ds_read_b64_tr_b16 v[112:113], v9 offset:9216
    v_mfma_f32_32x32x16_bf16 v[32:47], v[96:99], v[140:143], v[32:47]
    ds_read_b64_tr_b16 v[114:115], v9 offset:10240
    ds_read_b64_tr_b16 v[116:117], v10 offset:9216
    ds_read_b64_tr_b16 v[118:119], v10 offset:9728
    v_mfma_f32_32x32x16_bf16 v[48:63], v[100:103], v[136:139], v[48:63]
    v_mfma_f32_32x32x16_bf16 v[64:79], v[100:103], v[140:143], v[64:79]
    v_mfma_f32_32x32x16_bf16 v[80:95], v[104:107], v[136:139], v[80:95]
    s_waitcnt vmcnt(12) lgkmcnt(0)
    v_mfma_f32_32x32x16_bf16 v[16:31], v[108:111], v[144:147], v[16:31]
    ds_read_b64_tr_b16 v[96:97], v8 offset:12288
    ds_read_b64_tr_b16 v[98:99], v8 offset:13312
    ds_read_b64_tr_b16 v[100:101], v9 offset:12288
    v_mfma_f32_32x32x16_bf16 v[32:47], v[108:111], v[148:151], v[32:47]
    ds_read_b64_tr_b16 v[102:103], v9 offset:13312
    ds_read_b64_tr_b16 v[104:105], v10 offset:12288
    ds_read_b64_tr_b16 v[106:107], v10 offset:12800
    v_mfma_f32_32x32x16_bf16 v[48:63], v[112:115], v[144:147], v[48:63]
    v_mfma_f32_32x32x16_bf16 v[64:79], v[112:115], v[148:151], v[64:79]
    v_mfma_f32_32x32x16_bf16 v[80:95], v[116:119], v[144:147], v[80:95]
    s_waitcnt vmcnt(10) lgkmcnt(0)
    v_mfma_f32_32x32x16_bf16 v[16:31], v[96:99], v[152:155], v[16:31]
    ds_read_b64_tr_b16 v[108:109], v8 offset:15360
    ds_read_b64_tr_b16 v[110:111], v8 offset:16384
    ds_read_b64_tr_b16 v[112:113], v9 offset:15360
    v_mfma_f32_32x32x16_bf16 v[32:47], v[96:99], v[156:159], v[32:47]
    ds_read_b64_tr_b16 v[114:115], v9 offset:16384
    ds_read_b64_tr_b16 v[116:117], v10 offset:15360
    ds_read_b64_tr_b16 v[118:119], v10 offset:15872
    v_mfma_f32_32x32x16_bf16 v[48:63], v[100:103], v[152:155], v[48:63]
    v_mfma_f32_32x32x16_bf16 v[64:79], v[100:103], v[156:159], v[64:79]
    v_mfma_f32_32x32x16_bf16 v[80:95], v[104:107], v[152:155], v[80:95]
    s_waitcnt vmcnt(8) lgkmcnt(0)
    v_mfma_f32_32x32x16_bf16 v[16:31], v[108:111], v[160:163], v[16:31]
    ds_read_b64_tr_b16 v[96:97], v8 offset:18432
    ds_read_b64_tr_b16 v[98:99], v8 offset:19456
    ds_read_b64_tr_b16 v[100:101], v9 offset:18432
    v_mfma_f32_32x32x16_bf16 v[32:47], v[108:111], v[164:167], v[32:47]
    ds_read_b64_tr_b16 v[102:103], v9 offset:19456
    ds_read_b64_tr_b16 v[104:105], v10 offset:18432
    ds_read_b64_tr_b16 v[106:107], v10 offset:18944
    v_mfma_f32_32x32x16_bf16 v[48:63], v[112:115], v[160:163], v[48:63]
    v_mfma_f32_32x32x16_bf16 v[64:79], v[112:115], v[164:167], v[64:79]
    v_mfma_f32_32x32x16_bf16 v[80:95], v[116:119], v[160:163], v[80:95]
    s_waitcnt vmcnt(6) lgkmcnt(0)
    v_mfma_f32_32x32x16_bf16 v[16:31], v[96:99], v[168:171], v[16:31]
    ds_read_b64_tr_b16 v[108:109], v8 offset:21504
    ds_read_b64_tr_b16 v[110:111], v8 offset:22528
    ds_read_b64_tr_b16 v[112:113], v9 offset:21504
    v_mfma_f32_32x32x16_bf16 v[32:47], v[96:99], v[172:175], v[32:47]
    ds_read_b64_tr_b16 v[114:115], v9 offset:22528
    ds_read_b64_tr_b16 v[116:117], v10 offset:21504
    ds_read_b64_tr_b16 v[118:119], v10 offset:22016
    v_mfma_f32_32x32x16_bf16 v[48:63], v[100:103], v[168:171], v[48:63]
    v_mfma_f32_32x32x16_bf16 v[64:79], v[100:103], v[172:175], v[64:79]
    v_mfma_f32_32x32x16_bf16 v[80:95], v[104:107], v[168:171], v[80:95]
    s_waitcnt vmcnt(4) lgkmcnt(0)
    v_mfma_f32_32x32x16_bf16 v[16:31], v[108:111], v[176:179], v[16:31]
    ds_read_b64_tr_b16 v[96:97], v8 offset:24576
    ds_read_b64_tr_b16 v[98:99], v8 offset:25600
    ds_read_b64_tr_b16 v[100:101], v9 offset:24576
    v_mfma_f32_32x32x16_bf16 v[32:47], v[108:111], v[180:183], v[32:47]
    ds_read_b64_tr_b16 v[102:103], v9 offset:25600
    ds_read_b64_tr_b16 v[104:105], v10 offset:24576
    ds_read_b64_tr_b16 v[106:107], v10 offset:25088
    v_mfma_f32_32x32x16_bf16 v[48:63], v[112:115], v[176:179], v[48:63]
    v_mfma_f32_32x32x16_bf16 v[64:79], v[112:115], v[180:183], v[64:79]
    v_mfma_f32_32x32x16_bf16 v[80:95], v[116:119], v[176:179], v[80:95]
    s_waitcnt vmcnt(2) lgkmcnt(0)
    v_mfma_f32_32x32x16_bf16 v[16:31], v[96:99], v[184:187], v[16:31]
    ds_read_b64_tr_b16 v[108:109], v8 offset:0
    ds_read_b64_tr_b16 v[110:111], v8 offset:1024
    ds_read_b64_tr_b16 v[112:113], v9 offset:0
    v_mfma_f32_32x32x16_bf16 v[32:47], v[96:99], v[188:191], v[32:47]
    ds_read_b64_tr_b16 v[114:115], v9 offset:1024
    ds_read_b64_tr_b16 v[116:117], v10 offset:0
    ds_read_b64_tr_b16 v[118:119], v10 offset:512
    v_mfma_f32_32x32x16_bf16 v[48:63], v[100:103], v[184:187], v[48:63]
    v_mfma_f32_32x32x16_bf16 v[64:79], v[100:103], v[188:191], v[64:79]
    v_mfma_f32_32x32x16_bf16 v[80:95], v[104:107], v[184:187], v[80:95]
    s_waitcnt vmcnt(0) lgkmcnt(0)
    v_mfma_f32_32x32x16_bf16 v[16:31], v[108:111], v[192:195], v[16:31]
    v_mfma_f32_32x32x16_bf16 v[32:47], v[108:111], v[196:199], v[32:47]
    v_mfma_f32_32x32x16_bf16 v[48:63], v[112:115], v[192:195], v[48:63]
    v_mfma_f32_32x32x16_bf16 v[64:79], v[112:115], v[196:199], v[64:79]
    v_mfma_f32_32x32x16_bf16 v[80:95], v[116:119], v[192:195], v[80:95]
    s_nop 7
    ds_write_b128 v11, v[16:19] offset:0
    ds_write_b128 v11, v[20:23] offset:1024
    ds_write_b128 v11, v[24:27] offset:2048
    ds_write_b128 v11, v[28:31] offset:3072
    ds_write_b128 v11, v[32:35] offset:4096
    ds_write_b128 v11, v[36:39] offset:5120
    ds_write_b128 v11, v[40:43] offset:6144
    ds_write_b128 v11, v[44:47] offset:7168
    ds_write_b128 v11, v[48:51] offset:8192
    ds_write_b128 v11, v[52:55] offset:9216
    ds_write_b128 v11, v[56:59] offset:10240
    ds_write_b128 v11, v[60:63] offset:11264
    ds_write_b128 v11, v[64:67] offset:12288
    ds_write_b128 v11, v[68:71] offset:13312
    s_waitcnt lgkmcnt(7)
    ds_write_b128 v11, v[72:75] offset:14336
    ds_write_b128 v11, v[76:79] offset:15360
    ds_write_b128 v11, v[80:83] offset:16384
    ds_write_b128 v11, v[84:87] offset:17408
    ds_write_b128 v11, v[88:91] offset:18432
    ds_write_b128 v11, v[92:95] offset:19456
    s_waitcnt lgkmcnt(0)
    ds_add_u32 v242, v244 offset:28
    s_mov_b32 s62, 0
L_spin_82:
    ds_read_b32 v246, v243 offset:28
    s_waitcnt lgkmcnt(0)
    v_cmp_gt_u32 vcc, 12, v246
    s_cbranch_vccz L_spind_83
    s_add_u32 s62, s62, 1
    s_cmp_lt_u32 s62, 400000
    s_cbranch_scc1 L_spin_82
L_spind_83:
    ds_read_b128 v[16:19], v12 offset:0
    ds_read_b128 v[20:23], v12 offset:1024
    ds_read_b128 v[24:27], v12 offset:2048
    ds_read_b128 v[28:31], v12 offset:3072
    ds_read_b128 v[32:35], v254 offset:0
    ds_read_b128 v[36:39], v12 offset:29696
    ds_read_b128 v[40:43], v12 offset:30720
    ds_read_b128 v[44:47], v12 offset:31744
    ds_read_b128 v[48:51], v12 offset:32768
    ds_read_b128 v[52:55], v254 offset:29696
    ds_read_b128 v[56:59], v13 offset:0
    ds_read_b128 v[60:63], v13 offset:1024
    ds_read_b128 v[64:67], v13 offset:2048
    ds_read_b128 v[68:71], v13 offset:3072
    ds_read_b128 v[72:75], v255 offset:0
    s_waitcnt lgkmcnt(5)
    ds_read_b128 v[76:79], v13 offset:29696
    ds_read_b128 v[80:83], v13 offset:30720
    ds_read_b128 v[84:87], v13 offset:31744
    ds_read_b128 v[88:91], v13 offset:32768
    ds_read_b128 v[92:95], v255 offset:29696
    v_pk_add_f32 v[96:97], v[16:17], v[36:37]
    v_pk_add_f32 v[98:99], v[18:19], v[38:39]
    v_pk_add_f32 v[100:101], v[20:21], v[40:41]
    v_pk_add_f32 v[102:103], v[22:23], v[42:43]
    v_pk_add_f32 v[104:105], v[24:25], v[44:45]
    v_pk_add_f32 v[106:107], v[26:27], v[46:47]
    v_pk_add_f32 v[108:109], v[28:29], v[48:49]
    v_pk_add_f32 v[110:111], v[30:31], v[50:51]
    v_pk_add_f32 v[112:113], v[32:33], v[52:53]
    v_pk_add_f32 v[114:115], v[34:35], v[54:55]
    s_waitcnt lgkmcnt(5)
    v_pk_add_f32 v[96:97], v[96:97], v[56:57]
    v_pk_add_f32 v[98:99], v[98:99], v[58:59]
    v_pk_add_f32 v[100:101], v[100:101], v[60:61]
    v_pk_add_f32 v[102:103], v[102:103], v[62:63]
    v_pk_add_f32 v[104:105], v[104:105], v[64:65]
    v_pk_add_f32 v[106:107], v[106:107], v[66:67]
    v_pk_add_f32 v[108:109], v[108:109], v[68:69]
    v_pk_add_f32 v[110:111], v[110:111], v[70:71]
    v_pk_add_f32 v[112:113], v[112:113], v[72:73]
    v_pk_add_f32 v[114:115], v[114:115], v[74:75]
    s_waitcnt lgkmcnt(0)
    v_pk_add_f32 v[96:97], v[96:97], v[76:77]
    v_pk_add_f32 v[98:99], v[98:99], v[78:79]
    v_pk_add_f32 v[100:101], v[100:101], v[80:81]
    v_pk_add_f32 v[102:103], v[102:103], v[82:83]
    v_pk_add_f32 v[104:105], v[104:105], v[84:85]
    v_pk_add_f32 v[106:107], v[106:107], v[86:87]
    v_pk_add_f32 v[108:109], v[108:109], v[88:89]
    v_pk_add_f32 v[110:111], v[110:111], v[90:91]
    v_pk_add_f32 v[112:113], v[112:113], v[92:93]
    v_pk_add_f32 v[114:115], v[114:115], v[94:95]
    s_mov_b32 s62, 0xffff0000
    v_lshrrev_b32 v44, 5, v0
    v_lshl_add_u32 v44, v44, 3, v14
    v_lshlrev_b32 v16, 16, v220
    v_and_b32 v17, s62, v220
    v_lshlrev_b32 v18, 16, v221
    v_and_b32 v19, s62, v221
    v_pk_fma_f32 v[16:17], v[96:97], v[200:201], v[16:17]
    v_pk_fma_f32 v[18:19], v[98:99], v[202:203], v[18:19]
    v_cvt_pk_bf16_f32 v24, v16, v17
    v_cvt_pk_bf16_f32 v25, v18, v19
    v_lshlrev_b32 v20, 16, v222
    v_and_b32 v21, s62, v222
    v_lshlrev_b32 v22, 16, v223
    v_and_b32 v23, s62, v223
    v_pk_fma_f32 v[20:21], v[100:101], v[204:205], v[20:21]
    v_pk_fma_f32 v[22:23], v[102:103], v[206:207], v[22:23]
    v_cvt_pk_bf16_f32 v26, v20, v21
    v_cvt_pk_bf16_f32 v27, v22, v23
    s_nop 1
    v_permlane32_swap_b32 v24, v26
    v_permlane32_swap_b32 v25, v27
    buffer_store_dwordx4 v[24:27], v44, s[32:35], s88 offen offset:0
    v_lshlrev_b32 v16, 16, v224
    v_and_b32 v17, s62, v224
    v_lshlrev_b32 v18, 16, v225
    v_and_b32 v19, s62, v225
    v_pk_fma_f32 v[16:17], v[104:105], v[208:209], v[16:17]
    v_pk_fma_f32 v[18:19], v[106:107], v[210:211], v[18:19]
    v_cvt_pk_bf16_f32 v28, v16, v17
    v_cvt_pk_bf16_f32 v29, v18, v19
    v_lshlrev_b32 v20, 16, v226
    v_and_b32 v21, s62, v226
    v_lshlrev_b32 v22, 16, v227
    v_and_b32 v23, s62, v227
    v_pk_fma_f32 v[20:21], v[108:109], v[212:213], v[20:21]
    v_pk_fma_f32 v[22:23], v[110:111], v[214:215], v[22:23]
    v_cvt_pk_bf16_f32 v30, v20, v21
    v_cvt_pk_bf16_f32 v31, v22, v23
    s_nop 1
    v_permlane32_swap_b32 v28, v30
    v_permlane32_swap_b32 v29, v31
    buffer_store_dwordx4 v[28:31], v44, s[32:35], s88 offen offset:32
    v_lshlrev_b32 v16, 16, v228
    v_and_b32 v17, s62, v228
    v_lshlrev_b32 v18, 16, v229
    v_and_b32 v19, s62, v229
    v_pk_fma_f32 v[16:17], v[112:113], v[216:217], v[16:17]
    v_pk_fma_f32 v[18:19], v[114:115], v[218:219], v[18:19]
    v_cvt_pk_bf16_f32 v32, v16, v17
    v_cvt_pk_bf16_f32 v33, v18, v19
    buffer_store_dwordx2 v[32:33], v14, s[32:35], s89 offen
    s_branch L_END
L_END:
    s_endpgm
.section .rodata,"a"
.p2align 6
.amdhsa_kernel recurrent_scan__grouped_kv_mqa__dense_activation_relu__prompt_kernel
  .amdhsa_next_free_vgpr 256
  .amdhsa_next_free_sgpr 102
  .amdhsa_accum_offset 256
  .amdhsa_group_segment_fixed_size 0
  .amdhsa_kernarg_size 88
  .amdhsa_user_sgpr_count 2
  .amdhsa_user_sgpr_kernarg_segment_ptr 1
  .amdhsa_system_sgpr_workgroup_id_x 1
  .amdhsa_float_denorm_mode_32 3
.end_amdhsa_kernel
```
